```python
import torch

def _softmax(x, axis=-1):
    return torch.softmax(x, dim=axis)

def _gelu(x):
    return torch.nn.functional.gelu(x, approximate='tanh')

def _silu(x):
    return torch.nn.functional.silu(x)

def _sigmoid(x):
    return torch.sigmoid(x)

def _layernorm(x, axis=-1, eps=1e-05):
    m = x.mean(dim=axis, keepdim=True)
    v = x.var(dim=axis, keepdim=True, unbiased=False)
    return (x - m) / torch.sqrt(v + eps)

def _scatter_add(tgt, idx, src, axis=0):
    return tgt.clone().index_add_(axis, idx, src)

def _segment_sum(src, seg, n):
    out = torch.zeros((n,) + src.shape[1:], dtype=src.dtype)
    return out.index_add_(0, seg, src)

def _pad(x, pw):
    flat = tuple((v for pair in reversed(pw) for v in pair))
    return torch.nn.functional.pad(x, flat)
kernel_name = 'adaLN_cond__gqa_block_cached__swiglu_ffn__decode'

def setup_inputs():

    _w = lambda a: (lambda t: t.to(torch.bfloat16) if t.is_floating_point() else t)(torch.as_tensor(a))

    def _A_setup():
        B, Sq, D = (2, 1, 448)
        Hq, Hkv, Sk, Dh = (16, 8, 8192, 256)
        assert Hq % Hkv == 0, (Hq, Hkv)
        return {'x': _w((lambda *s: torch.randn(*s, dtype=torch.bfloat16) * 0.05)(B, Sq, D)), 'k_cache': _w((lambda *s: torch.randn(*s, dtype=torch.bfloat16) * 3.2)(B, Hkv, Sk, Dh)), 'v_cache': _w((lambda *s: torch.randn(*s, dtype=torch.bfloat16) * 0.4)(B, Hkv, Sk, Dh)), 'wq': _w((lambda *s: torch.randn(*s, dtype=torch.bfloat16) * 3.2)(D, Hq * Dh) * D ** (-0.5)), 'wo': _w((lambda *s: torch.randn(*s, dtype=torch.bfloat16) * 0.4)(Hq * Dh, D) * (Hq * Dh) ** (-0.5))}
    _A_in = _A_setup()

    def _B_setup():
        B, S, D, F = (2, 1, 448, 1792)
        return {'x': _w((lambda *s: torch.randn(*s, dtype=torch.bfloat16) * 0.05)(B, S, D)), 'w_gate': _w((lambda *s: torch.randn(*s, dtype=torch.bfloat16) * 0.05)(D, F)), 'w_up': _w((lambda *s: torch.randn(*s, dtype=torch.bfloat16) * 0.05)(D, F)), 'w_down': _w((lambda *s: torch.randn(*s, dtype=torch.bfloat16) * 0.05)(F, D))}
    _B_in = _B_setup()
    return {'A_x': _A_in['x'], 'A_k_cache': _A_in['k_cache'], 'A_v_cache': _A_in['v_cache'], 'A_wq': _A_in['wq'], 'A_wo': _A_in['wo'], 'B_x': _B_in['x'], 'B_w_gate': _B_in['w_gate'], 'B_w_up': _B_in['w_up'], 'B_w_down': _B_in['w_down'], 'c': _w((lambda *s: torch.randn(*s, dtype=torch.bfloat16) * 0.2)(2, 448) * 8.0), 'w_mod': _w((lambda *s: torch.randn(*s, dtype=torch.bfloat16) * 0.2)(448, 6 * 448) * 448 ** (-0.5) * 8.0)}

def reference(A_x, A_k_cache, A_v_cache, A_wq, A_wo, B_x, B_w_gate, B_w_up, B_w_down, c, w_mod):

    def _A_ref(x, k_cache, v_cache, wq, wo):
        B, Sq, D = x.shape
        Hq, Dh = (16, 256)
        Hkv = k_cache.shape[1]
        rep = Hq // Hkv
        q = (lambda x, *d: x.permute(*d))((x @ wq).reshape(B, Sq, Hq, Dh), 0, 2, 1, 3)
        k = (lambda x, n, axis: torch.repeat_interleave(x, n, dim=axis))(k_cache, rep, axis=1)
        v = (lambda x, n, axis: torch.repeat_interleave(x, n, dim=axis))(v_cache, rep, axis=1)
        scores = torch.einsum('bhqd,bhkd->bhqk', q, k) * Dh ** (-0.5)
        p = _softmax(scores, axis=-1)
        o = torch.einsum('bhqk,bhkd->bhqd', p, v)
        return (lambda x, *d: x.permute(*d))(o, 0, 2, 1, 3).reshape(B, Sq, Hq * Dh) @ wo

    def _B_ref(x, w_gate, w_up, w_down):
        g = _silu(x @ w_gate)
        u = x @ w_up
        return g * u @ w_down
    x = A_x
    mod = (_silu(c) @ w_mod).reshape(c.shape[0], 6, 1, -1)
    sa, ca, ga, sb, cb, gb = (mod[:, 0].clone(), mod[:, 1].clone(), mod[:, 2].clone(), mod[:, 3].clone(), mod[:, 4].clone(), mod[:, 5].clone())
    h = _layernorm(x, axis=-1) * (1 + ca) + sa
    x = x + ga * _A_ref(h, A_k_cache, A_v_cache, A_wq, A_wo)
    h = _layernorm(x, axis=-1) * (1 + cb) + sb
    x = x + gb * _B_ref(h, B_w_gate, B_w_up, B_w_down)
    return x
```

```asm
; @launch grid=(256,1,1) block=(512,1,1) lds=49152
.amdgcn_target "amdgcn-amd-amdhsa--gfx950"
.text
.globl adaLN_cond__gqa_block_cached__swiglu_ffn__decode_kernel
.p2align 8
.type adaLN_cond__gqa_block_cached__swiglu_ffn__decode_kernel,@function
adaLN_cond__gqa_block_cached__swiglu_ffn__decode_kernel:
    s_cmp_ge_u32 s2, 256
    s_cbranch_scc1 L_end
    s_load_dwordx16 s[4:19], s[0:1], 0
    s_load_dwordx8 s[20:27], s[0:1], 64
    s_load_dwordx2 s[30:31], s[0:1], 104
    s_sub_u32 s68, s2, 224
    s_cmp_ge_u32 s68, 16
    s_cbranch_scc1 L_nopf
    s_getpc_b64 s[68:69]
L_pc:
    s_sub_u32 s68, s68, L_pc-adaLN_cond__gqa_block_cached__swiglu_ffn__decode_kernel
    s_subb_u32 s69, s69, 0
    v_lshlrev_b32 v16, 4, v0
    global_load_dwordx4 v[192:195], v16, s[68:69]
    v_add_u32 v16, 8192, v16
    global_load_dwordx4 v[196:199], v16, s[68:69]
    v_add_u32 v16, 8192, v16
    global_load_dwordx4 v[200:203], v16, s[68:69]
L_nopf:
    v_lshrrev_b32 v17, 6, v0
    v_and_b32 v0, 63, v0
    v_readfirstlane_b32 s48, v17
    s_and_b32 s68, s2, 7
    s_lshr_b32 s69, s2, 3
    s_lshr_b32 s70, s69, 4
    s_and_b32 s52, s69, 15
    s_lshl_b32 s54, s70, 3
    s_add_u32 s54, s54, s68
    s_lshr_b32 s49, s2, 1
    s_and_b32 s50, s2, 1
    s_lshl_b32 s28, s50, 7
    s_add_u32 s28, s28, s49
    s_and_b32 s51, s48, 3
    s_sub_u32 s60, s28, 0
    s_sub_u32 s68, s60, 24
    s_cmp_lt_u32 s68, 8
    s_cselect_b32 s60, 99, s60
    s_sub_u32 s68, s28, 184
    s_add_u32 s69, s68, 24
    s_cmp_lt_u32 s68, 8
    s_cselect_b32 s60, s69, s60
    s_sub_u32 s59, s60, 24
    s_cmp_lt_u32 s60, 64
    s_cselect_b32 s1, 1, 0
    s_sub_u32 s68, s28, 92
    s_cmp_lt_u32 s68, 14
    s_cselect_b32 s1, 1, s1
    s_sub_u32 s68, s28, 64
    s_cmp_lt_u32 s68, 28
    s_cselect_b32 s1, 1, s1
    v_and_b32 v1, 15, v0
    v_lshrrev_b32 v2, 4, v0
    v_and_b32 v3, 7, v0
    v_bfe_u32 v4, v0, 3, 1
    v_lshrrev_b32 v5, 2, v1
    v_lshlrev_b32 v5, 9, v5
    v_lshl_add_u32 v5, v2, 6, v5
    v_and_b32 v17, 3, v1
    v_lshl_add_u32 v5, v17, 4, v5
    v_lshlrev_b32 v6, 9, v2
    v_lshl_add_u32 v6, v1, 4, v6
    s_lshl_b32 s68, s54, 22
    s_lshl_b32 s69, s52, 18
    s_add_u32 s68, s68, s69
    s_lshr_b32 s69, s48, 2
    s_lshl_b32 s69, s69, 17
    s_add_u32 s68, s68, s69
    s_lshl_b32 s69, s51, 11
    s_add_u32 s56, s68, s69
    s_mov_b32 s34, 0x4000000
    s_mov_b32 s35, 0x20000
    s_lshl_b32 s68, s51, 2
    s_add_u32 s68, s68, 32
    v_mov_b32 v7, s68
    v_mov_b32 v63, 0
    s_cmp_ge_u32 s48, 4
    s_cbranch_scc1 L_hi
    v_mov_b32 v24, 0
    v_mov_b32 v25, 0
    v_lshlrev_b32 v23, 3, v0
    s_cmp_lg_u32 s48, 0
    s_cbranch_scc1 L_nz
    ds_write_b64 v23, v[24:25]
L_nz:
    s_mov_b32 s49, s60
    s_cmp_lt_u32 s49, 64
    s_cbranch_scc0 L_noq
    s_lshr_b32 s68, s49, 3
    s_add_u32 s68, s68, 0
    s_and_b32 s68, s68, 7
    s_and_b32 s49, s49, 7
    s_lshl_b32 s49, s49, 3
    s_add_u32 s49, s49, s68
    s_lshl_b32 s69, s49, 7
    s_mov_b32 s66, 3670016
    s_mov_b32 s67, 0x20000
    v_lshrrev_b32 v21, 3, v0
    v_mul_u32_u24 v16, 56, v21
    s_mul_i32 s72, s51, 14
    v_add_u32 v16, s72, v16
    v_mul_u32_u24 v17, 8192, v16
    v_lshl_add_u32 v17, v3, 4, v17
    v_min_u32 v22, 6, v3
    v_lshl_add_u32 v20, v22, 1, v16
    s_lshl_b32 s72, s48, 10
    s_add_u32 s72, s72, 1024
    v_lshlrev_b32 v21, 6, v21
    v_add_u32 v21, s72, v21
    v_lshl_add_u32 v22, v22, 3, v21
    v_lshlrev_b32 v18, 1, v20
    v_mul_u32_u24 v19, 28, v0
    s_waitcnt lgkmcnt(0)
    global_load_dword v63, v63, s[30:31] sc1
    s_mov_b32 s32, s6
    s_and_b32 s33, s7, 0xffff
    s_mov_b32 s64, s10
    s_and_b32 s65, s11, 0xffff
    s_mov_b32 s15, 1
    s_cmp_eq_u32 s1, 0
    s_cselect_b64 vcc, 1, 0
    s_nop 4
    global_load_dword v248, v18, s[4:5]
    global_load_dword v249, v18, s[4:5] offset:896
    global_load_dwordx4 v[56:59], v19, s[4:5]
    global_load_dwordx3 v[60:62], v19, s[4:5] offset:16
    s_mov_b32 s62, s69
    s_waitcnt vmcnt(5)
    buffer_load_dwordx4 v[192:195], v17, s[64:67], s69 offen nt
    s_add_u32 s69, s69, 8192
    s_waitcnt vmcnt(5)
    buffer_load_dwordx4 v[196:199], v17, s[64:67], s69 offen nt
    s_add_u32 s69, s69, 8192
    s_waitcnt vmcnt(5)
    buffer_load_dwordx4 v[200:203], v17, s[64:67], s69 offen nt
    s_add_u32 s69, s69, 8192
    s_barrier
    s_waitcnt vmcnt(5)
    buffer_load_dwordx4 v[204:207], v17, s[64:67], s69 offen nt
    s_add_u32 s69, s69, 8192
    s_waitcnt vmcnt(5)
    buffer_load_dwordx4 v[208:211], v17, s[64:67], s69 offen nt
    s_add_u32 s69, s69, 8192
    s_waitcnt vmcnt(5)
    buffer_load_dwordx4 v[212:215], v17, s[64:67], s69 offen nt
    s_add_u32 s69, s69, 8192
    s_waitcnt vmcnt(5)
    buffer_load_dwordx4 v[216:219], v17, s[64:67], s69 offen nt
    s_add_u32 s69, s69, 8192
    s_waitcnt vmcnt(5)
    buffer_load_dwordx4 v[220:223], v17, s[64:67], s69 offen nt
    s_add_u32 s69, s69, 8192
    s_waitcnt vmcnt(5)
    buffer_load_dwordx4 v[224:227], v17, s[64:67], s69 offen nt
    s_add_u32 s69, s69, 8192
    s_waitcnt vmcnt(5)
    buffer_load_dwordx4 v[228:231], v17, s[64:67], s69 offen nt
    s_add_u32 s69, s69, 8192
    s_waitcnt vmcnt(5)
    buffer_load_dwordx4 v[232:235], v17, s[64:67], s69 offen nt
    s_add_u32 s69, s69, 8192
    s_waitcnt vmcnt(5)
    buffer_load_dwordx4 v[236:239], v17, s[64:67], s69 offen nt
    s_add_u32 s69, s69, 8192
    s_waitcnt vmcnt(5)
    buffer_load_dwordx4 v[240:243], v17, s[64:67], s69 offen nt
    s_add_u32 s69, s69, 8192
    s_waitcnt vmcnt(5)
    buffer_load_dwordx4 v[244:247], v17, s[64:67], s69 offen nt
    s_branch L_oldk
L_noq:
    v_mov_b32 v18, 0
    v_mov_b32 v19, 0
    s_mov_b32 s66, 0
    s_mov_b32 s67, 0x20000
    s_mov_b32 s62, 0
    s_waitcnt lgkmcnt(0)
    global_load_dword v63, v63, s[30:31] sc1
    s_mov_b32 s32, s6
    s_and_b32 s33, s7, 0xffff
    s_mov_b32 s64, s10
    s_and_b32 s65, s11, 0xffff
    s_mov_b32 s15, 0
    s_cmp_eq_u32 s1, 0
    s_cselect_b64 vcc, 1, 0
    s_nop 4
    s_cmp_eq_u32 s1, 0
    s_cbranch_scc1 L_oldk
    s_barrier
L_oldk:
    s_waitcnt vmcnt(6)
    s_cmp_lt_u32 s59, 8
    s_cbranch_scc1 Lw_1
    s_waitcnt vmcnt(5)
    s_cbranch_vccz Lw_1
    s_waitcnt vmcnt(4)
Lw_1:
    s_add_u32 s57, s56, 0
    buffer_load_dwordx4 v[64:67], v5, s[32:35], s57 offen offset:0 nt
    s_waitcnt vmcnt(6)
    s_cmp_lt_u32 s59, 8
    s_cbranch_scc1 Lw_2
    s_waitcnt vmcnt(5)
    s_cbranch_vccz Lw_2
    s_waitcnt vmcnt(4)
Lw_2:
    buffer_load_dwordx4 v[68:71], v5, s[32:35], s57 offen offset:256 nt
    s_waitcnt vmcnt(6)
    s_cmp_lt_u32 s59, 8
    s_cbranch_scc1 Lw_3
    s_waitcnt vmcnt(5)
    s_cbranch_vccz Lw_3
    s_waitcnt vmcnt(4)
Lw_3:
    s_add_u32 s57, s56, 8192
    buffer_load_dwordx4 v[72:75], v5, s[32:35], s57 offen offset:0 nt
    s_waitcnt vmcnt(6)
    s_cmp_lt_u32 s59, 8
    s_cbranch_scc1 Lw_4
    s_waitcnt vmcnt(5)
    s_cbranch_vccz Lw_4
    s_waitcnt vmcnt(4)
Lw_4:
    buffer_load_dwordx4 v[76:79], v5, s[32:35], s57 offen offset:256 nt
    s_waitcnt vmcnt(6)
    s_cmp_lt_u32 s59, 8
    s_cbranch_scc1 Lw_5
    s_waitcnt vmcnt(5)
    s_cbranch_vccz Lw_5
    s_waitcnt vmcnt(4)
Lw_5:
    s_add_u32 s57, s56, 16384
    buffer_load_dwordx4 v[80:83], v5, s[32:35], s57 offen offset:0 nt
    s_cmp_lg_u32 s1, 0
    s_cbranch_scc1 L_nb2
    s_barrier
L_nb2:
    s_mov_b32 s36, s8
    s_and_b32 s37, s9, 0xffff
    s_mov_b32 s38, 0x4000000
    s_mov_b32 s39, 0x20000
    s_mov_b32 s40, s12
    s_and_b32 s41, s13, 0xffff
    s_mov_b32 s42, 3670016
    s_mov_b32 s43, 0x20000
    s_mov_b32 s44, s20
    s_and_b32 s45, s21, 0xffff
    s_mov_b32 s46, 1605632
    s_mov_b32 s47, 0x20000
    s_add_u32 s8, s30, 0x1fffff
    s_addc_u32 s9, s31, 0
    s_and_b32 s8, s8, 0xffe00000
    s_lshl_b32 s6, s2, 8
    s_add_u32 s6, s6, 1179648
    s_add_u32 s6, s30, s6
    s_addc_u32 s7, s31, 0
    s_mov_b32 s14, 0xffff0000
    s_mov_b32 s3, 0x3db8aa3b
    v_and_b32 v31, 1, v3
    v_cmp_eq_u32 vcc, 1, v31
    v_mov_b32 v28, 0x0c0c0100
    v_mov_b32 v29, 0x01000c0c
    v_cndmask_b32 v28, v28, v29, vcc
    v_mov_b32 v30, 0x0c0c0302
    v_mov_b32 v29, 0x03020c0c
    v_cndmask_b32 v30, v30, v29, vcc
    v_mov_b32 v29, 0x0c0c0c0c
    v_lshrrev_b32 v31, 1, v3
    v_cmp_eq_u32 vcc, 0, v31
    s_nop 1
    v_cndmask_b32 v8, v29, v28, vcc
    v_cndmask_b32 v12, v29, v30, vcc
    v_cmp_eq_u32 vcc, 1, v31
    s_nop 1
    v_cndmask_b32 v9, v29, v28, vcc
    v_cndmask_b32 v13, v29, v30, vcc
    v_cmp_eq_u32 vcc, 2, v31
    s_nop 1
    v_cndmask_b32 v10, v29, v28, vcc
    v_cndmask_b32 v14, v29, v30, vcc
    v_cmp_eq_u32 vcc, 3, v31
    s_nop 1
    v_cndmask_b32 v11, v29, v28, vcc
    v_cndmask_b32 v15, v29, v30, vcc
    s_cmp_eq_u32 s1, 0
    s_cselect_b64 vcc, 1, 0
    s_nop 4
    s_cmp_eq_u32 s15, 0
    s_cbranch_scc1 L_noln
    s_waitcnt vmcnt(5)
    v_lshlrev_b32 v18, 3, v20
    v_add_u32 v18, 4096, v18
    v_add_u32 v19, 0x1000, v18
    v_lshlrev_b32 v32, 16, v56
    v_and_b32 v33, s14, v56
    v_lshlrev_b32 v34, 16, v57
    v_and_b32 v35, s14, v57
    v_lshlrev_b32 v36, 16, v58
    v_and_b32 v37, s14, v58
    v_lshlrev_b32 v38, 16, v59
    v_and_b32 v39, s14, v59
    v_lshlrev_b32 v40, 16, v60
    v_and_b32 v41, s14, v60
    v_lshlrev_b32 v42, 16, v61
    v_and_b32 v43, s14, v61
    v_lshlrev_b32 v44, 16, v62
    v_and_b32 v45, s14, v62
    v_add_f32 v50, v32, v33
    v_add_f32 v51, v34, v35
    v_add_f32 v50, v50, v36
    v_add_f32 v51, v51, v37
    v_add_f32 v50, v50, v38
    v_add_f32 v51, v51, v39
    v_add_f32 v50, v50, v40
    v_add_f32 v51, v51, v41
    v_add_f32 v50, v50, v42
    v_add_f32 v51, v51, v43
    v_add_f32 v50, v50, v44
    v_add_f32 v51, v51, v45
    v_add_f32 v50, v50, v51
    s_nop 1
    v_add_f32_dpp v50, v50, v50 quad_perm:[1,0,3,2] row_mask:0xf bank_mask:0xf
    s_nop 1
    v_add_f32_dpp v50, v50, v50 quad_perm:[2,3,0,1] row_mask:0xf bank_mask:0xf
    s_nop 1
    v_add_f32_dpp v50, v50, v50 row_half_mirror row_mask:0xf bank_mask:0xf
    s_nop 1
    v_add_f32_dpp v50, v50, v50 row_mirror row_mask:0xf bank_mask:0xf
    v_mov_b32 v51, v50
    s_nop 1
    v_permlane16_swap_b32 v50, v51
    v_add_f32 v50, v50, v51
    v_mul_f32 v48, 0x3b124925, v50
    v_sub_f32 v32, v32, v48
    v_sub_f32 v33, v33, v48
    v_sub_f32 v34, v34, v48
    v_sub_f32 v35, v35, v48
    v_sub_f32 v36, v36, v48
    v_sub_f32 v37, v37, v48
    v_sub_f32 v38, v38, v48
    v_sub_f32 v39, v39, v48
    v_sub_f32 v40, v40, v48
    v_sub_f32 v41, v41, v48
    v_sub_f32 v42, v42, v48
    v_sub_f32 v43, v43, v48
    v_sub_f32 v44, v44, v48
    v_sub_f32 v45, v45, v48
    v_mul_f32 v50, v32, v32
    v_mul_f32 v51, v33, v33
    v_fmac_f32 v50, v34, v34
    v_fmac_f32 v51, v35, v35
    v_fmac_f32 v50, v36, v36
    v_fmac_f32 v51, v37, v37
    v_fmac_f32 v50, v38, v38
    v_fmac_f32 v51, v39, v39
    v_fmac_f32 v50, v40, v40
    v_fmac_f32 v51, v41, v41
    v_fmac_f32 v50, v42, v42
    v_fmac_f32 v51, v43, v43
    v_fmac_f32 v50, v44, v44
    v_fmac_f32 v51, v45, v45
    v_add_f32 v50, v50, v51
    s_nop 1
    v_add_f32_dpp v50, v50, v50 quad_perm:[1,0,3,2] row_mask:0xf bank_mask:0xf
    s_nop 1
    v_add_f32_dpp v50, v50, v50 quad_perm:[2,3,0,1] row_mask:0xf bank_mask:0xf
    s_nop 1
    v_add_f32_dpp v50, v50, v50 row_half_mirror row_mask:0xf bank_mask:0xf
    s_nop 1
    v_add_f32_dpp v50, v50, v50 row_mirror row_mask:0xf bank_mask:0xf
    v_mov_b32 v51, v50
    s_nop 1
    v_permlane16_swap_b32 v50, v51
    v_add_f32 v50, v50, v51
    v_mul_f32 v50, 0x3b124925, v50
    v_cvt_pk_bf16_f32 v50, v48, v50
    v_lshlrev_b32 v48, 16, v50
    v_and_b32 v50, s14, v50
    v_add_f32 v50, 0x3727c5ac, v50
    v_cvt_pk_bf16_f32 v50, v50, v50
    v_and_b32 v50, s14, v50
    v_sqrt_f32 v50, v50
    s_nop 0
    v_cvt_pk_bf16_f32 v50, v50, v50
    v_and_b32 v50, s14, v50
    v_rcp_f32 v49, v50
    v_mov_b32 v50, v48
    v_mov_b32 v51, v49
    s_nop 0
    v_permlane32_swap_b32 v48, v50
    v_permlane32_swap_b32 v49, v51
    v_lshlrev_b32 v56, 16, v248
    v_and_b32 v57, s14, v248
    v_lshlrev_b32 v58, 16, v249
    v_and_b32 v59, s14, v249
    v_sub_f32 v56, v56, v48
    v_sub_f32 v57, v57, v48
    v_sub_f32 v58, v58, v50
    v_sub_f32 v59, v59, v50
    v_cvt_pk_bf16_f32 v57, v56, v57
    v_lshlrev_b32 v56, 16, v57
    v_and_b32 v57, s14, v57
    v_cvt_pk_bf16_f32 v59, v58, v59
    v_lshlrev_b32 v58, 16, v59
    v_and_b32 v59, s14, v59
    v_mul_f32 v56, v56, v49
    v_mul_f32 v57, v57, v49
    v_mul_f32 v58, v58, v51
    v_mul_f32 v59, v59, v51
    v_cvt_pk_bf16_f32 v57, v56, v57
    v_lshlrev_b32 v56, 16, v57
    v_and_b32 v57, s14, v57
    v_cvt_pk_bf16_f32 v59, v58, v59
    v_lshlrev_b32 v58, 16, v59
    v_and_b32 v59, s14, v59
L_noln:
    s_waitcnt vmcnt(6)
    s_cmp_lt_u32 s59, 8
    s_cbranch_scc1 Lw_6
    s_waitcnt vmcnt(5)
    s_cbranch_vccz Lw_6
    s_waitcnt vmcnt(4)
Lw_6:
    buffer_load_dwordx4 v[84:87], v5, s[32:35], s57 offen offset:256 nt
    s_waitcnt vmcnt(6)
    s_cmp_lt_u32 s59, 8
    s_cbranch_scc1 Lw_7
    s_waitcnt vmcnt(5)
    s_cbranch_vccz Lw_7
    s_waitcnt vmcnt(4)
Lw_7:
    s_add_u32 s57, s56, 24576
    buffer_load_dwordx4 v[88:91], v5, s[32:35], s57 offen offset:0 nt
    s_waitcnt vmcnt(6)
    s_cmp_lt_u32 s59, 8
    s_cbranch_scc1 Lw_8
    s_waitcnt vmcnt(5)
    s_cbranch_vccz Lw_8
    s_waitcnt vmcnt(4)
Lw_8:
    buffer_load_dwordx4 v[92:95], v5, s[32:35], s57 offen offset:256 nt
    s_waitcnt vmcnt(6)
    s_cmp_lt_u32 s59, 8
    s_cbranch_scc1 Lw_9
    s_waitcnt vmcnt(5)
    s_cbranch_vccz Lw_9
    s_waitcnt vmcnt(4)
Lw_9:
    s_add_u32 s57, s56, 32768
    buffer_load_dwordx4 v[96:99], v5, s[32:35], s57 offen offset:0 nt
    s_waitcnt vmcnt(6)
    s_cmp_lt_u32 s59, 8
    s_cbranch_scc1 Lw_10
    s_waitcnt vmcnt(5)
    s_cbranch_vccz Lw_10
    s_waitcnt vmcnt(4)
Lw_10:
    buffer_load_dwordx4 v[100:103], v5, s[32:35], s57 offen offset:256 nt
    s_waitcnt vmcnt(6)
    s_cmp_lt_u32 s59, 8
    s_cbranch_scc1 Lw_11
    s_waitcnt vmcnt(5)
    s_cbranch_vccz Lw_11
    s_waitcnt vmcnt(4)
Lw_11:
    s_add_u32 s57, s56, 40960
    buffer_load_dwordx4 v[104:107], v5, s[32:35], s57 offen offset:0 nt
    s_waitcnt vmcnt(6)
    s_cmp_lt_u32 s59, 8
    s_cbranch_scc1 Lw_12
    s_waitcnt vmcnt(5)
    s_cbranch_vccz Lw_12
    s_waitcnt vmcnt(4)
Lw_12:
    buffer_load_dwordx4 v[108:111], v5, s[32:35], s57 offen offset:256 nt
    s_waitcnt vmcnt(6)
    s_cmp_lt_u32 s59, 8
    s_cbranch_scc1 Lw_13
    s_waitcnt vmcnt(5)
    s_cbranch_vccz Lw_13
    s_waitcnt vmcnt(4)
Lw_13:
    s_add_u32 s57, s56, 49152
    buffer_load_dwordx4 v[112:115], v5, s[32:35], s57 offen offset:0 nt
    v_readfirstlane_b32 s53, v63
    s_nop 0
    s_mul_i32 s53, s53, 0x0019660d
    s_add_u32 s53, s53, 0x3c6ef35f
    s_waitcnt vmcnt(6)
    s_cmp_lt_u32 s59, 8
    s_cbranch_scc1 Lw_14
    s_waitcnt vmcnt(5)
    s_cbranch_vccz Lw_14
    s_waitcnt vmcnt(4)
Lw_14:
    buffer_load_dwordx4 v[116:119], v5, s[32:35], s57 offen offset:256 nt
    s_waitcnt vmcnt(6)
    s_cmp_lt_u32 s59, 8
    s_cbranch_scc1 Lw_15
    s_waitcnt vmcnt(5)
    s_cbranch_vccz Lw_15
    s_waitcnt vmcnt(4)
Lw_15:
    s_add_u32 s57, s56, 57344
    buffer_load_dwordx4 v[120:123], v5, s[32:35], s57 offen offset:0 nt
    s_waitcnt vmcnt(6)
    s_cmp_lt_u32 s59, 8
    s_cbranch_scc1 Lw_16
    s_waitcnt vmcnt(5)
    s_cbranch_vccz Lw_16
    s_waitcnt vmcnt(4)
Lw_16:
    buffer_load_dwordx4 v[124:127], v5, s[32:35], s57 offen offset:256 nt
    s_cmp_lg_u32 s15, 1
    s_cbranch_scc1 Lm_17
    s_load_dwordx16 s[68:83], s[6:7], 0 glc
Lm_17:
    s_waitcnt vmcnt(6)
    s_cmp_lt_u32 s59, 8
    s_cbranch_scc1 Lw_18
    s_waitcnt vmcnt(5)
    s_cbranch_vccz Lw_18
    s_waitcnt vmcnt(4)
Lw_18:
    s_add_u32 s57, s56, 65536
    buffer_load_dwordx4 v[128:131], v5, s[32:35], s57 offen offset:0 nt
    s_waitcnt vmcnt(6)
    s_cmp_lt_u32 s59, 8
    s_cbranch_scc1 Lw_19
    s_waitcnt vmcnt(5)
    s_cbranch_vccz Lw_19
    s_waitcnt vmcnt(4)
Lw_19:
    buffer_load_dwordx4 v[132:135], v5, s[32:35], s57 offen offset:256 nt
    s_waitcnt vmcnt(6)
    s_cmp_lt_u32 s59, 8
    s_cbranch_scc1 Lw_20
    s_waitcnt vmcnt(5)
    s_cbranch_vccz Lw_20
    s_waitcnt vmcnt(4)
Lw_20:
    s_add_u32 s57, s56, 73728
    buffer_load_dwordx4 v[136:139], v5, s[32:35], s57 offen offset:0 nt
    s_waitcnt vmcnt(6)
    s_cmp_lt_u32 s59, 8
    s_cbranch_scc1 Lw_21
    s_waitcnt vmcnt(5)
    s_cbranch_vccz Lw_21
    s_waitcnt vmcnt(4)
Lw_21:
    buffer_load_dwordx4 v[140:143], v5, s[32:35], s57 offen offset:256 nt
    s_waitcnt vmcnt(6)
    s_cmp_lt_u32 s59, 8
    s_cbranch_scc1 Lw_22
    s_waitcnt vmcnt(5)
    s_cbranch_vccz Lw_22
    s_waitcnt vmcnt(4)
Lw_22:
    s_add_u32 s57, s56, 81920
    buffer_load_dwordx4 v[144:147], v5, s[32:35], s57 offen offset:0 nt
    s_cmp_lg_u32 s15, 1
    s_cbranch_scc1 Lm_23
    s_waitcnt lgkmcnt(0)
    s_xor_b32 s68, s68, s53
    s_xor_b32 s69, s69, s53
    s_xor_b32 s70, s70, s53
    s_xor_b32 s71, s71, s53
    s_xor_b32 s72, s72, s53
    s_xor_b32 s73, s73, s53
    s_xor_b32 s74, s74, s53
    s_xor_b32 s75, s75, s53
    s_xor_b32 s76, s76, s53
    s_xor_b32 s77, s77, s53
    s_xor_b32 s78, s78, s53
    s_xor_b32 s79, s79, s53
    s_xor_b32 s80, s80, s53
    s_xor_b32 s81, s81, s53
    s_or_b64 s[68:69], s[68:69], s[70:71]
    s_or_b64 s[68:69], s[68:69], s[72:73]
    s_or_b64 s[68:69], s[68:69], s[74:75]
    s_or_b64 s[68:69], s[68:69], s[76:77]
    s_or_b64 s[68:69], s[68:69], s[78:79]
    s_or_b64 s[68:69], s[68:69], s[80:81]
    s_cmp_eq_u64 s[68:69], 0
    s_cbranch_scc0 Lm_23
    global_load_dwordx4 v[24:27], v18, s[30:31] sc1
    global_load_dwordx4 v[28:31], v19, s[30:31] sc1
    s_mov_b32 s15, 2
Lm_23:
    s_waitcnt vmcnt(6)
    s_cmp_lt_u32 s59, 8
    s_cbranch_scc1 Lw_24
    s_waitcnt vmcnt(5)
    s_cbranch_vccz Lw_24
    s_waitcnt vmcnt(4)
Lw_24:
    buffer_load_dwordx4 v[148:151], v5, s[32:35], s57 offen offset:256 nt
    s_cmp_lg_u32 s15, 1
    s_cbranch_scc1 Lm_25
    s_load_dwordx16 s[68:83], s[6:7], 0 glc
Lm_25:
    s_waitcnt vmcnt(6)
    s_cmp_lt_u32 s59, 8
    s_cbranch_scc1 Lw_26
    s_waitcnt vmcnt(5)
    s_cbranch_vccz Lw_26
    s_waitcnt vmcnt(4)
Lw_26:
    s_add_u32 s57, s56, 90112
    buffer_load_dwordx4 v[152:155], v5, s[32:35], s57 offen offset:0 nt
    s_waitcnt vmcnt(6)
    s_cmp_lt_u32 s59, 8
    s_cbranch_scc1 Lw_27
    s_waitcnt vmcnt(5)
    s_cbranch_vccz Lw_27
    s_waitcnt vmcnt(4)
Lw_27:
    buffer_load_dwordx4 v[156:159], v5, s[32:35], s57 offen offset:256 nt
    s_waitcnt vmcnt(6)
    s_cmp_lt_u32 s59, 8
    s_cbranch_scc1 Lw_28
    s_waitcnt vmcnt(5)
    s_cbranch_vccz Lw_28
    s_waitcnt vmcnt(4)
Lw_28:
    s_add_u32 s57, s56, 98304
    buffer_load_dwordx4 v[160:163], v5, s[32:35], s57 offen offset:0 nt
    s_waitcnt vmcnt(6)
    s_cmp_lt_u32 s59, 8
    s_cbranch_scc1 Lw_29
    s_waitcnt vmcnt(5)
    s_cbranch_vccz Lw_29
    s_waitcnt vmcnt(4)
Lw_29:
    buffer_load_dwordx4 v[164:167], v5, s[32:35], s57 offen offset:256 nt
    s_waitcnt vmcnt(6)
    s_cmp_lt_u32 s59, 8
    s_cbranch_scc1 Lw_30
    s_waitcnt vmcnt(5)
    s_cbranch_vccz Lw_30
    s_waitcnt vmcnt(4)
Lw_30:
    s_add_u32 s57, s56, 106496
    buffer_load_dwordx4 v[168:171], v5, s[32:35], s57 offen offset:0 nt
    s_cmp_lg_u32 s15, 1
    s_cbranch_scc1 Lm_31
    s_waitcnt lgkmcnt(0)
    s_xor_b32 s68, s68, s53
    s_xor_b32 s69, s69, s53
    s_xor_b32 s70, s70, s53
    s_xor_b32 s71, s71, s53
    s_xor_b32 s72, s72, s53
    s_xor_b32 s73, s73, s53
    s_xor_b32 s74, s74, s53
    s_xor_b32 s75, s75, s53
    s_xor_b32 s76, s76, s53
    s_xor_b32 s77, s77, s53
    s_xor_b32 s78, s78, s53
    s_xor_b32 s79, s79, s53
    s_xor_b32 s80, s80, s53
    s_xor_b32 s81, s81, s53
    s_or_b64 s[68:69], s[68:69], s[70:71]
    s_or_b64 s[68:69], s[68:69], s[72:73]
    s_or_b64 s[68:69], s[68:69], s[74:75]
    s_or_b64 s[68:69], s[68:69], s[76:77]
    s_or_b64 s[68:69], s[68:69], s[78:79]
    s_or_b64 s[68:69], s[68:69], s[80:81]
    s_cmp_eq_u64 s[68:69], 0
    s_cbranch_scc0 Lm_31
    global_load_dwordx4 v[24:27], v18, s[30:31] sc1
    global_load_dwordx4 v[28:31], v19, s[30:31] sc1
    s_mov_b32 s15, 2
Lm_31:
    s_waitcnt vmcnt(6)
    s_cmp_lt_u32 s59, 8
    s_cbranch_scc1 Lw_32
    s_waitcnt vmcnt(5)
    s_cbranch_vccz Lw_32
    s_waitcnt vmcnt(4)
Lw_32:
    buffer_load_dwordx4 v[172:175], v5, s[32:35], s57 offen offset:256 nt
    s_waitcnt vmcnt(6)
    s_cmp_lt_u32 s59, 8
    s_cbranch_scc1 Lw_33
    s_waitcnt vmcnt(5)
    s_cbranch_vccz Lw_33
    s_waitcnt vmcnt(4)
Lw_33:
    s_add_u32 s57, s56, 114688
    buffer_load_dwordx4 v[176:179], v5, s[32:35], s57 offen offset:0 nt
    v_mov_b32 v23, s15
    ds_write_b32 v7, v23 offset:32
    v_mov_b32 v16, 1
    ds_max_u32 v7, v16
    s_waitcnt vmcnt(6)
    s_cmp_lt_u32 s59, 8
    s_cbranch_scc1 Lw_34
    s_waitcnt vmcnt(5)
    s_cbranch_vccz Lw_34
    s_waitcnt vmcnt(4)
Lw_34:
    buffer_load_dwordx4 v[180:183], v5, s[32:35], s57 offen offset:256 nt
    s_waitcnt vmcnt(6)
    s_cmp_lt_u32 s59, 8
    s_cbranch_scc1 Lw_35
    s_waitcnt vmcnt(5)
    s_cbranch_vccz Lw_35
    s_waitcnt vmcnt(4)
Lw_35:
    s_add_u32 s57, s56, 122880
    buffer_load_dwordx4 v[184:187], v5, s[32:35], s57 offen offset:0 nt
    s_waitcnt vmcnt(6)
    s_cmp_lt_u32 s59, 8
    s_cbranch_scc1 Lw_36
    s_waitcnt vmcnt(5)
    s_cbranch_vccz Lw_36
    s_waitcnt vmcnt(4)
Lw_36:
    buffer_load_dwordx4 v[188:191], v5, s[32:35], s57 offen offset:256 nt
    s_cmp_eq_u32 s15, 0
    s_cbranch_scc1 L_wait
    s_mov_b32 s55, 0
    s_cmp_eq_u32 s15, 1
    s_cbranch_scc1 L_mw
    s_waitcnt vmcnt(5)
    s_branch L_mchk
L_mw:
    s_load_dwordx16 s[68:83], s[6:7], 0 glc
    s_add_u32 s55, s55, 1
    s_cmp_gt_u32 s55, 3000000
    s_cbranch_scc1 L_exit
    s_waitcnt lgkmcnt(0)
    s_xor_b32 s68, s68, s53
    s_xor_b32 s69, s69, s53
    s_xor_b32 s70, s70, s53
    s_xor_b32 s71, s71, s53
    s_xor_b32 s72, s72, s53
    s_xor_b32 s73, s73, s53
    s_xor_b32 s74, s74, s53
    s_xor_b32 s75, s75, s53
    s_xor_b32 s76, s76, s53
    s_xor_b32 s77, s77, s53
    s_xor_b32 s78, s78, s53
    s_xor_b32 s79, s79, s53
    s_xor_b32 s80, s80, s53
    s_xor_b32 s81, s81, s53
    s_or_b64 s[68:69], s[68:69], s[70:71]
    s_or_b64 s[68:69], s[68:69], s[72:73]
    s_or_b64 s[68:69], s[68:69], s[74:75]
    s_or_b64 s[68:69], s[68:69], s[76:77]
    s_or_b64 s[68:69], s[68:69], s[78:79]
    s_or_b64 s[68:69], s[68:69], s[80:81]
    s_and_b32 s70, s55, 63
    s_cselect_b64 s[68:69], s[68:69], 0
    s_cmp_eq_u64 s[68:69], 0
    s_cbranch_scc0 L_mw
    global_load_dwordx4 v[24:27], v18, s[30:31] sc1
    global_load_dwordx4 v[28:31], v19, s[30:31] sc1
    s_waitcnt vmcnt(0)
L_mchk:
    v_cmp_ne_u32 s[74:75], s53, v25
    v_cmp_ne_u32 s[78:79], s53, v27
    s_nop 0
    s_or_b64 s[74:75], s[74:75], s[78:79]
    v_cmp_ne_u32 s[80:81], s53, v29
    s_nop 0
    s_or_b64 s[74:75], s[74:75], s[80:81]
    v_cmp_ne_u32 s[76:77], s53, v31
    s_nop 0
    s_or_b64 s[74:75], s[74:75], s[76:77]
    s_cmp_eq_u64 s[74:75], 0
    s_cbranch_scc1 Lok_37
    s_add_u32 s55, s55, 1
    s_cmp_gt_u32 s55, 3000000
    s_cbranch_scc1 L_exit
    s_branch L_mw
Lok_37:
    v_lshlrev_b32 v48, 16, v28
    v_and_b32 v49, s14, v28
    v_lshlrev_b32 v50, 16, v30
    v_and_b32 v51, s14, v30
    v_mul_f32 v56, v56, v48
    v_mul_f32 v57, v57, v49
    v_mul_f32 v58, v58, v50
    v_mul_f32 v59, v59, v51
    v_cvt_pk_bf16_f32 v57, v56, v57
    v_lshlrev_b32 v56, 16, v57
    v_and_b32 v57, s14, v57
    v_cvt_pk_bf16_f32 v59, v58, v59
    v_lshlrev_b32 v58, 16, v59
    v_and_b32 v59, s14, v59
    v_lshlrev_b32 v48, 16, v24
    v_and_b32 v49, s14, v24
    v_lshlrev_b32 v50, 16, v26
    v_and_b32 v51, s14, v26
    v_add_f32 v56, v56, v48
    v_add_f32 v57, v57, v49
    v_add_f32 v58, v58, v50
    v_add_f32 v59, v59, v51
    v_cvt_pk_bf16_f32 v24, v56, v58
    v_cvt_pk_bf16_f32 v26, v57, v59
    s_branch L_g64
L_hi:
    s_sub_u32 s49, s28, 92
    s_cmp_lt_u32 s49, 14
    s_cbranch_scc1 L_role
    s_sub_u32 s68, s28, 64
    s_add_u32 s49, s68, 14
    s_cmp_lt_u32 s68, 28
    s_cbranch_scc1 L_role
L_norole:
    s_waitcnt lgkmcnt(0)
    global_load_dword v63, v63, s[30:31] sc1
    s_mov_b32 s32, s6
    s_and_b32 s33, s7, 0xffff
    s_barrier
    s_mov_b32 s36, s8
    s_and_b32 s37, s9, 0xffff
    s_mov_b32 s38, 0x4000000
    s_mov_b32 s39, 0x20000
    s_mov_b32 s40, s12
    s_and_b32 s41, s13, 0xffff
    s_mov_b32 s42, 3670016
    s_mov_b32 s43, 0x20000
    s_mov_b32 s44, s20
    s_and_b32 s45, s21, 0xffff
    s_mov_b32 s46, 1605632
    s_mov_b32 s47, 0x20000
    s_add_u32 s8, s30, 0x1fffff
    s_addc_u32 s9, s31, 0
    s_and_b32 s8, s8, 0xffe00000
    s_lshl_b32 s6, s2, 8
    s_add_u32 s6, s6, 1179648
    s_add_u32 s6, s30, s6
    s_addc_u32 s7, s31, 0
    s_mov_b32 s14, 0xffff0000
    s_mov_b32 s3, 0x3db8aa3b
    v_and_b32 v31, 1, v3
    v_cmp_eq_u32 vcc, 1, v31
    v_mov_b32 v28, 0x0c0c0100
    v_mov_b32 v29, 0x01000c0c
    v_cndmask_b32 v28, v28, v29, vcc
    v_mov_b32 v30, 0x0c0c0302
    v_mov_b32 v29, 0x03020c0c
    v_cndmask_b32 v30, v30, v29, vcc
    v_mov_b32 v29, 0x0c0c0c0c
    v_lshrrev_b32 v31, 1, v3
    v_cmp_eq_u32 vcc, 0, v31
    s_nop 1
    v_cndmask_b32 v8, v29, v28, vcc
    v_cndmask_b32 v12, v29, v30, vcc
    v_cmp_eq_u32 vcc, 1, v31
    s_nop 1
    v_cndmask_b32 v9, v29, v28, vcc
    v_cndmask_b32 v13, v29, v30, vcc
    v_cmp_eq_u32 vcc, 2, v31
    s_nop 1
    v_cndmask_b32 v10, v29, v28, vcc
    v_cndmask_b32 v14, v29, v30, vcc
    v_cmp_eq_u32 vcc, 3, v31
    s_nop 1
    v_cndmask_b32 v11, v29, v28, vcc
    v_cndmask_b32 v15, v29, v30, vcc
    s_cmp_lg_u32 s28, 127
    s_cbranch_scc1 L_nsig
    s_cmp_lg_u32 s48, 7
    s_cbranch_scc1 L_nsig
    s_mov_b32 s68, -1
    s_mov_b32 s69, -1
    s_mov_b32 s76, 4079616
    s_mov_b32 s77, 4087808
    s_memtime s[70:71]
    s_waitcnt lgkmcnt(0)
    s_load_dword s74, s[8:9], s76 glc
    s_waitcnt lgkmcnt(0)
    s_memtime s[72:73]
    s_waitcnt lgkmcnt(0)
    s_sub_u32 s72, s72, s70
    s_min_u32 s68, s68, s72
    s_memtime s[70:71]
    s_waitcnt lgkmcnt(0)
    s_load_dword s74, s[8:9], s77 glc
    s_waitcnt lgkmcnt(0)
    s_memtime s[72:73]
    s_waitcnt lgkmcnt(0)
    s_sub_u32 s72, s72, s70
    s_min_u32 s69, s69, s72
    s_memtime s[70:71]
    s_waitcnt lgkmcnt(0)
    s_load_dword s74, s[8:9], s76 glc
    s_waitcnt lgkmcnt(0)
    s_memtime s[72:73]
    s_waitcnt lgkmcnt(0)
    s_sub_u32 s72, s72, s70
    s_min_u32 s68, s68, s72
    s_memtime s[70:71]
    s_waitcnt lgkmcnt(0)
    s_load_dword s74, s[8:9], s77 glc
    s_waitcnt lgkmcnt(0)
    s_memtime s[72:73]
    s_waitcnt lgkmcnt(0)
    s_sub_u32 s72, s72, s70
    s_min_u32 s69, s69, s72
    s_memtime s[70:71]
    s_waitcnt lgkmcnt(0)
    s_load_dword s74, s[8:9], s76 glc
    s_waitcnt lgkmcnt(0)
    s_memtime s[72:73]
    s_waitcnt lgkmcnt(0)
    s_sub_u32 s72, s72, s70
    s_min_u32 s68, s68, s72
    s_memtime s[70:71]
    s_waitcnt lgkmcnt(0)
    s_load_dword s74, s[8:9], s77 glc
    s_waitcnt lgkmcnt(0)
    s_memtime s[72:73]
    s_waitcnt lgkmcnt(0)
    s_sub_u32 s72, s72, s70
    s_min_u32 s69, s69, s72
    s_memtime s[70:71]
    s_waitcnt lgkmcnt(0)
    s_load_dword s74, s[8:9], s76 glc
    s_waitcnt lgkmcnt(0)
    s_memtime s[72:73]
    s_waitcnt lgkmcnt(0)
    s_sub_u32 s72, s72, s70
    s_min_u32 s68, s68, s72
    s_memtime s[70:71]
    s_waitcnt lgkmcnt(0)
    s_load_dword s74, s[8:9], s77 glc
    s_waitcnt lgkmcnt(0)
    s_memtime s[72:73]
    s_waitcnt lgkmcnt(0)
    s_sub_u32 s72, s72, s70
    s_min_u32 s69, s69, s72
    s_getreg_b32 s70, hwreg(HW_REG_XCC_ID)
    s_bfe_u32 s70, s70, 0x10002
    s_cmp_lt_u32 s69, s68
    s_cselect_b32 s71, 1, 0
    s_xor_b32 s70, s70, s71
    s_lshl_b32 s70, s70, 13
    s_waitcnt vmcnt(0)
    v_readfirstlane_b32 s53, v63
    s_nop 0
    s_mul_i32 s53, s53, 0x0019660d
    s_add_u32 s53, s53, 0x3c6ef35f
    v_mov_b32 v16, s70
    v_mov_b32 v17, s53
    v_mov_b32 v18, 2048
    s_mov_b64 exec, 1
    global_store_dwordx2 v18, v[16:17], s[30:31] sc1
    s_mov_b64 exec, -1
    s_branch L_young
L_nsig:
    s_waitcnt vmcnt(0)
    v_readfirstlane_b32 s53, v63
    s_nop 0
    s_mul_i32 s53, s53, 0x0019660d
    s_add_u32 s53, s53, 0x3c6ef35f
    s_branch L_young
L_role:
    s_lshl_b32 s69, s49, 7
    s_mov_b32 s66, 2408448
    s_mov_b32 s67, 0x20000
    v_lshrrev_b32 v21, 3, v0
    v_mul_u32_u24 v16, 56, v21
    s_mul_i32 s72, s51, 14
    v_add_u32 v16, s72, v16
    v_mul_u32_u24 v17, 5376, v16
    v_lshl_add_u32 v17, v3, 4, v17
    v_min_u32 v22, 6, v3
    v_lshl_add_u32 v20, v22, 1, v16
    s_lshl_b32 s72, s48, 10
    s_add_u32 s72, s72, 1024
    v_lshlrev_b32 v21, 6, v21
    v_add_u32 v21, s72, v21
    v_lshl_add_u32 v22, v22, 3, v21
    v_lshlrev_b32 v18, 1, v20
    s_waitcnt lgkmcnt(0)
    global_load_dword v63, v63, s[30:31] sc1
    s_mov_b32 s64, s24
    s_and_b32 s65, s25, 0xffff
    global_load_dword v248, v18, s[22:23]
    global_load_dword v249, v18, s[22:23] offset:896
    buffer_load_dwordx4 v[192:195], v17, s[64:67], s69 offen nt
    s_add_u32 s69, s69, 5376
    buffer_load_dwordx4 v[196:199], v17, s[64:67], s69 offen nt
    s_add_u32 s69, s69, 5376
    buffer_load_dwordx4 v[200:203], v17, s[64:67], s69 offen nt
    s_add_u32 s69, s69, 5376
    buffer_load_dwordx4 v[204:207], v17, s[64:67], s69 offen nt
    s_add_u32 s69, s69, 5376
    buffer_load_dwordx4 v[208:211], v17, s[64:67], s69 offen nt
    s_add_u32 s69, s69, 5376
    buffer_load_dwordx4 v[212:215], v17, s[64:67], s69 offen nt
    s_add_u32 s69, s69, 5376
    buffer_load_dwordx4 v[216:219], v17, s[64:67], s69 offen nt
    s_add_u32 s69, s69, 5376
    buffer_load_dwordx4 v[220:223], v17, s[64:67], s69 offen nt
    s_add_u32 s69, s69, 5376
    buffer_load_dwordx4 v[224:227], v17, s[64:67], s69 offen nt
    s_add_u32 s69, s69, 5376
    buffer_load_dwordx4 v[228:231], v17, s[64:67], s69 offen nt
    s_add_u32 s69, s69, 5376
    buffer_load_dwordx4 v[232:235], v17, s[64:67], s69 offen nt
    s_add_u32 s69, s69, 5376
    buffer_load_dwordx4 v[236:239], v17, s[64:67], s69 offen nt
    s_add_u32 s69, s69, 5376
    buffer_load_dwordx4 v[240:243], v17, s[64:67], s69 offen nt
    s_add_u32 s69, s69, 5376
    buffer_load_dwordx4 v[244:247], v17, s[64:67], s69 offen nt
    s_barrier
    s_mov_b32 s32, s6
    s_and_b32 s33, s7, 0xffff
    s_mov_b32 s36, s8
    s_and_b32 s37, s9, 0xffff
    s_mov_b32 s38, 0x4000000
    s_mov_b32 s39, 0x20000
    s_mov_b32 s40, s12
    s_and_b32 s41, s13, 0xffff
    s_mov_b32 s42, 3670016
    s_mov_b32 s43, 0x20000
    s_mov_b32 s44, s20
    s_and_b32 s45, s21, 0xffff
    s_mov_b32 s46, 1605632
    s_mov_b32 s47, 0x20000
    s_add_u32 s8, s30, 0x1fffff
    s_addc_u32 s9, s31, 0
    s_and_b32 s8, s8, 0xffe00000
    s_lshl_b32 s6, s2, 8
    s_add_u32 s6, s6, 1179648
    s_add_u32 s6, s30, s6
    s_addc_u32 s7, s31, 0
    s_mov_b32 s14, 0xffff0000
    s_mov_b32 s3, 0x3db8aa3b
    v_and_b32 v31, 1, v3
    v_cmp_eq_u32 vcc, 1, v31
    v_mov_b32 v28, 0x0c0c0100
    v_mov_b32 v29, 0x01000c0c
    v_cndmask_b32 v28, v28, v29, vcc
    v_mov_b32 v30, 0x0c0c0302
    v_mov_b32 v29, 0x03020c0c
    v_cndmask_b32 v30, v30, v29, vcc
    v_mov_b32 v29, 0x0c0c0c0c
    v_lshrrev_b32 v31, 1, v3
    v_cmp_eq_u32 vcc, 0, v31
    s_nop 1
    v_cndmask_b32 v8, v29, v28, vcc
    v_cndmask_b32 v12, v29, v30, vcc
    v_cmp_eq_u32 vcc, 1, v31
    s_nop 1
    v_cndmask_b32 v9, v29, v28, vcc
    v_cndmask_b32 v13, v29, v30, vcc
    v_cmp_eq_u32 vcc, 2, v31
    s_nop 1
    v_cndmask_b32 v10, v29, v28, vcc
    v_cndmask_b32 v14, v29, v30, vcc
    v_cmp_eq_u32 vcc, 3, v31
    s_nop 1
    v_cndmask_b32 v11, v29, v28, vcc
    v_cndmask_b32 v15, v29, v30, vcc
    s_waitcnt vmcnt(14)
    v_readfirstlane_b32 s53, v63
    s_nop 0
    s_mul_i32 s53, s53, 0x0019660d
    s_add_u32 s53, s53, 0x3c6ef35f
    v_lshlrev_b32 v24, 16, v248
    v_lshlrev_b32 v25, 16, v249
    v_and_b32 v26, s14, v248
    v_and_b32 v27, s14, v249
    v_mul_f32 v28, 0xbfb8aa3b, v24
    v_mul_f32 v29, 0xbfb8aa3b, v25
    v_mul_f32 v30, 0xbfb8aa3b, v26
    v_mul_f32 v31, 0xbfb8aa3b, v27
    v_exp_f32 v28, v28
    v_exp_f32 v29, v29
    v_exp_f32 v30, v30
    v_exp_f32 v31, v31
    v_add_f32 v28, 1.0, v28
    v_add_f32 v29, 1.0, v29
    v_add_f32 v30, 1.0, v30
    v_add_f32 v31, 1.0, v31
    v_rcp_f32 v28, v28
    v_rcp_f32 v29, v29
    v_rcp_f32 v30, v30
    v_rcp_f32 v31, v31
    v_mul_f32 v24, v24, v28
    v_mul_f32 v25, v25, v29
    v_mul_f32 v26, v26, v30
    v_mul_f32 v27, v27, v31
    v_cvt_pk_bf16_f32 v24, v24, v25
    v_cvt_pk_bf16_f32 v26, v26, v27
L_g64:
    ds_write2_b32 v22, v24, v26 offset0:0 offset1:1
    ds_read_b128 v[32:35], v21 offset:0
    ds_read_b128 v[36:39], v21 offset:16
    ds_read_b128 v[40:43], v21 offset:32
    ds_read_b64 v[44:45], v21 offset:48
    s_cmp_lt_u32 s48, 4
    s_waitcnt lgkmcnt(0)
    v_perm_b32 v24, v32, v32, v8
    v_perm_b32 v25, v32, v32, v9
    v_perm_b32 v26, v32, v32, v10
    v_perm_b32 v27, v32, v32, v11
    s_cbranch_scc1 Lg_38
    s_waitcnt vmcnt(12)
Lg_38:
    v_perm_b32 v28, v32, v32, v12
    v_perm_b32 v29, v32, v32, v13
    v_perm_b32 v30, v32, v32, v14
    v_perm_b32 v31, v32, v32, v15
    v_mfma_f32_16x16x32_bf16 v[16:19], v[192:195], v[24:27], 0
    v_perm_b32 v48, v33, v33, v8
    v_perm_b32 v49, v33, v33, v9
    v_perm_b32 v50, v33, v33, v10
    v_perm_b32 v51, v33, v33, v11
    v_mfma_f32_16x16x32_bf16 v[20:23], v[192:195], v[28:31], 0
    v_perm_b32 v52, v33, v33, v12
    v_perm_b32 v53, v33, v33, v13
    v_perm_b32 v54, v33, v33, v14
    v_perm_b32 v55, v33, v33, v15
    v_mfma_f32_16x16x32_bf16 v[16:19], v[196:199], v[48:51], v[16:19]
    v_perm_b32 v24, v34, v34, v8
    v_perm_b32 v25, v34, v34, v9
    v_perm_b32 v26, v34, v34, v10
    v_perm_b32 v27, v34, v34, v11
    v_mfma_f32_16x16x32_bf16 v[20:23], v[196:199], v[52:55], v[20:23]
    s_cbranch_scc1 Lg_39
    s_waitcnt vmcnt(10)
Lg_39:
    v_perm_b32 v28, v34, v34, v12
    v_perm_b32 v29, v34, v34, v13
    v_perm_b32 v30, v34, v34, v14
    v_perm_b32 v31, v34, v34, v15
    v_mfma_f32_16x16x32_bf16 v[16:19], v[200:203], v[24:27], v[16:19]
    v_perm_b32 v48, v35, v35, v8
    v_perm_b32 v49, v35, v35, v9
    v_perm_b32 v50, v35, v35, v10
    v_perm_b32 v51, v35, v35, v11
    v_mfma_f32_16x16x32_bf16 v[20:23], v[200:203], v[28:31], v[20:23]
    v_perm_b32 v52, v35, v35, v12
    v_perm_b32 v53, v35, v35, v13
    v_perm_b32 v54, v35, v35, v14
    v_perm_b32 v55, v35, v35, v15
    v_mfma_f32_16x16x32_bf16 v[16:19], v[204:207], v[48:51], v[16:19]
    v_perm_b32 v24, v36, v36, v8
    v_perm_b32 v25, v36, v36, v9
    v_perm_b32 v26, v36, v36, v10
    v_perm_b32 v27, v36, v36, v11
    v_mfma_f32_16x16x32_bf16 v[20:23], v[204:207], v[52:55], v[20:23]
    s_cbranch_scc1 Lg_40
    s_waitcnt vmcnt(8)
Lg_40:
    v_perm_b32 v28, v36, v36, v12
    v_perm_b32 v29, v36, v36, v13
    v_perm_b32 v30, v36, v36, v14
    v_perm_b32 v31, v36, v36, v15
    v_mfma_f32_16x16x32_bf16 v[16:19], v[208:211], v[24:27], v[16:19]
    v_perm_b32 v48, v37, v37, v8
    v_perm_b32 v49, v37, v37, v9
    v_perm_b32 v50, v37, v37, v10
    v_perm_b32 v51, v37, v37, v11
    v_mfma_f32_16x16x32_bf16 v[20:23], v[208:211], v[28:31], v[20:23]
    v_perm_b32 v52, v37, v37, v12
    v_perm_b32 v53, v37, v37, v13
    v_perm_b32 v54, v37, v37, v14
    v_perm_b32 v55, v37, v37, v15
    v_mfma_f32_16x16x32_bf16 v[16:19], v[212:215], v[48:51], v[16:19]
    v_perm_b32 v24, v38, v38, v8
    v_perm_b32 v25, v38, v38, v9
    v_perm_b32 v26, v38, v38, v10
    v_perm_b32 v27, v38, v38, v11
    v_mfma_f32_16x16x32_bf16 v[20:23], v[212:215], v[52:55], v[20:23]
    s_cbranch_scc1 Lg_41
    s_waitcnt vmcnt(6)
Lg_41:
    v_perm_b32 v28, v38, v38, v12
    v_perm_b32 v29, v38, v38, v13
    v_perm_b32 v30, v38, v38, v14
    v_perm_b32 v31, v38, v38, v15
    v_mfma_f32_16x16x32_bf16 v[16:19], v[216:219], v[24:27], v[16:19]
    v_perm_b32 v48, v39, v39, v8
    v_perm_b32 v49, v39, v39, v9
    v_perm_b32 v50, v39, v39, v10
    v_perm_b32 v51, v39, v39, v11
    v_mfma_f32_16x16x32_bf16 v[20:23], v[216:219], v[28:31], v[20:23]
    v_perm_b32 v52, v39, v39, v12
    v_perm_b32 v53, v39, v39, v13
    v_perm_b32 v54, v39, v39, v14
    v_perm_b32 v55, v39, v39, v15
    v_mfma_f32_16x16x32_bf16 v[16:19], v[220:223], v[48:51], v[16:19]
    v_perm_b32 v24, v40, v40, v8
    v_perm_b32 v25, v40, v40, v9
    v_perm_b32 v26, v40, v40, v10
    v_perm_b32 v27, v40, v40, v11
    v_mfma_f32_16x16x32_bf16 v[20:23], v[220:223], v[52:55], v[20:23]
    s_cbranch_scc1 Lg_42
    s_waitcnt vmcnt(4)
Lg_42:
    v_perm_b32 v28, v40, v40, v12
    v_perm_b32 v29, v40, v40, v13
    v_perm_b32 v30, v40, v40, v14
    v_perm_b32 v31, v40, v40, v15
    v_mfma_f32_16x16x32_bf16 v[16:19], v[224:227], v[24:27], v[16:19]
    v_perm_b32 v48, v41, v41, v8
    v_perm_b32 v49, v41, v41, v9
    v_perm_b32 v50, v41, v41, v10
    v_perm_b32 v51, v41, v41, v11
    v_mfma_f32_16x16x32_bf16 v[20:23], v[224:227], v[28:31], v[20:23]
    v_perm_b32 v52, v41, v41, v12
    v_perm_b32 v53, v41, v41, v13
    v_perm_b32 v54, v41, v41, v14
    v_perm_b32 v55, v41, v41, v15
    v_mfma_f32_16x16x32_bf16 v[16:19], v[228:231], v[48:51], v[16:19]
    v_perm_b32 v24, v42, v42, v8
    v_perm_b32 v25, v42, v42, v9
    v_perm_b32 v26, v42, v42, v10
    v_perm_b32 v27, v42, v42, v11
    v_mfma_f32_16x16x32_bf16 v[20:23], v[228:231], v[52:55], v[20:23]
    s_cbranch_scc1 Lg_43
    s_waitcnt vmcnt(2)
Lg_43:
    v_perm_b32 v28, v42, v42, v12
    v_perm_b32 v29, v42, v42, v13
    v_perm_b32 v30, v42, v42, v14
    v_perm_b32 v31, v42, v42, v15
    v_mfma_f32_16x16x32_bf16 v[16:19], v[232:235], v[24:27], v[16:19]
    v_perm_b32 v48, v43, v43, v8
    v_perm_b32 v49, v43, v43, v9
    v_perm_b32 v50, v43, v43, v10
    v_perm_b32 v51, v43, v43, v11
    v_mfma_f32_16x16x32_bf16 v[20:23], v[232:235], v[28:31], v[20:23]
    v_perm_b32 v52, v43, v43, v12
    v_perm_b32 v53, v43, v43, v13
    v_perm_b32 v54, v43, v43, v14
    v_perm_b32 v55, v43, v43, v15
    v_mfma_f32_16x16x32_bf16 v[16:19], v[236:239], v[48:51], v[16:19]
    v_perm_b32 v24, v44, v44, v8
    v_perm_b32 v25, v44, v44, v9
    v_perm_b32 v26, v44, v44, v10
    v_perm_b32 v27, v44, v44, v11
    v_mfma_f32_16x16x32_bf16 v[20:23], v[236:239], v[52:55], v[20:23]
    s_cbranch_scc1 Lg_44
    s_waitcnt vmcnt(0)
Lg_44:
    v_perm_b32 v28, v44, v44, v12
    v_perm_b32 v29, v44, v44, v13
    v_perm_b32 v30, v44, v44, v14
    v_perm_b32 v31, v44, v44, v15
    v_mfma_f32_16x16x32_bf16 v[16:19], v[240:243], v[24:27], v[16:19]
    v_perm_b32 v48, v45, v45, v8
    v_perm_b32 v49, v45, v45, v9
    v_perm_b32 v50, v45, v45, v10
    v_perm_b32 v51, v45, v45, v11
    v_mfma_f32_16x16x32_bf16 v[20:23], v[240:243], v[28:31], v[20:23]
    v_perm_b32 v52, v45, v45, v12
    v_perm_b32 v53, v45, v45, v13
    v_perm_b32 v54, v45, v45, v14
    v_perm_b32 v55, v45, v45, v15
    v_mfma_f32_16x16x32_bf16 v[16:19], v[244:247], v[48:51], v[16:19]
    s_nop 0
    v_mfma_f32_16x16x32_bf16 v[20:23], v[244:247], v[52:55], v[20:23]
    v_lshrrev_b32 v24, 1, v2
    v_lshlrev_b32 v25, 9, v24
    v_lshl_add_u32 v25, v3, 5, v25
    v_and_b32 v26, 1, v2
    v_lshl_add_u32 v25, v26, 4, v25
    s_lshl_b32 s72, s51, 10
    v_add_u32 v25, s72, v25
    v_cmp_eq_u32 vcc, v24, v4
    s_nop 0
    s_and_saveexec_b64 s[82:83], vcc
    ds_write_b128 v25, v[16:19] offset:9216
    ds_write_b128 v25, v[20:23] offset:9472
    s_mov_b64 exec, 1
    v_mov_b32 v24, 0
    v_mov_b32 v26, 1
    s_waitcnt lgkmcnt(0)
    ds_add_u32 v24, v26 offset:0
    s_mov_b64 exec, -1
    s_cmp_lg_u32 s51, 3
    s_cbranch_scc1 L_rdone
    v_lshrrev_b32 v24, 5, v0
    v_lshlrev_b32 v24, 8, v24
    v_and_b32 v25, 3, v0
    v_lshl_add_u32 v24, v25, 6, v24
    v_bfe_u32 v25, v0, 2, 3
    v_lshl_add_u32 v24, v25, 2, v24
    v_add_u32 v24, 9216, v24
    v_lshrrev_b32 v18, 5, v0
    v_and_b32 v19, 31, v0
    v_mov_b32 v17, s53
    s_mov_b32 s70, 0
    s_cmp_lt_u32 s48, 4
    s_cbranch_scc1 L_finq
    s_mul_i32 s73, s49, 37
    s_lshr_b32 s73, s73, 8
    s_mul_i32 s69, s73, 7
    s_sub_u32 s69, s49, s69
    s_cmp_eq_u32 s73, 1
    s_cselect_b32 s70, 1, 0
    s_cmp_eq_u32 s73, 4
    s_cselect_b32 s70, 1, s70
    s_lshl_b32 s73, s73, 12
    s_lshl_b32 s69, s69, 9
    s_add_u32 s69, s69, s73
    s_add_u32 s69, s69, 4096
    v_lshlrev_b32 v18, 3, v18
    v_lshl_add_u32 v18, v19, 4, v18
    s_branch L_finsum
L_finq:
    s_lshl_b32 s69, s49, 8
    s_add_u32 s69, s69, 32768
    v_lshlrev_b32 v18, 14, v18
    v_lshl_add_u32 v18, v19, 3, v18
L_finsum:
    v_add_u32 v18, s69, v18
    v_mov_b32 v26, 0
    s_mov_b32 s55, 0
Lspin_45:
    ds_read_b32 v27, v26 offset:0
    s_add_u32 s55, s55, 1
    s_cmp_gt_u32 s55, 48000000
    s_cbranch_scc1 L_exit
    s_waitcnt lgkmcnt(0)
    v_readfirstlane_b32 s72, v27
    s_nop 0
    s_cmp_ge_u32 s72, 4
    s_cbranch_scc0 Lspin_45
    ds_read2_b32 v[32:33], v24 offset0:0 offset1:8
    v_add_u32 v24, 512, v24
    ds_read2_b32 v[34:35], v24 offset0:0 offset1:8
    v_add_u32 v24, 512, v24
    ds_read2_b32 v[36:37], v24 offset0:0 offset1:8
    v_add_u32 v24, 512, v24
    ds_read2_b32 v[38:39], v24 offset0:0 offset1:8
    v_add_u32 v24, 512, v24
    ds_read2_b32 v[40:41], v24 offset0:0 offset1:8
    v_add_u32 v24, 512, v24
    ds_read2_b32 v[42:43], v24 offset0:0 offset1:8
    v_add_u32 v24, 512, v24
    ds_read2_b32 v[44:45], v24 offset0:0 offset1:8
    v_add_u32 v24, 512, v24
    ds_read2_b32 v[46:47], v24 offset0:0 offset1:8
    s_waitcnt lgkmcnt(0)
    v_add_f32 v32, v32, v34
    v_add_f32 v33, v33, v35
    v_add_f32 v32, v32, v36
    v_add_f32 v33, v33, v37
    v_add_f32 v32, v32, v38
    v_add_f32 v33, v33, v39
    v_add_f32 v32, v32, v40
    v_add_f32 v33, v33, v41
    v_add_f32 v32, v32, v42
    v_add_f32 v33, v33, v43
    v_add_f32 v32, v32, v44
    v_add_f32 v33, v33, v45
    v_add_f32 v32, v32, v46
    v_add_f32 v33, v33, v47
    s_cmp_eq_u32 s70, 0
    s_cbranch_scc1 L_noadd
    v_cvt_pk_bf16_f32 v33, v32, v33
    v_lshlrev_b32 v32, 16, v33
    v_and_b32 v33, s14, v33
    v_add_f32 v32, 1.0, v32
    v_add_f32 v33, 1.0, v33
L_noadd:
    v_cvt_pk_bf16_f32 v16, v32, v33
    global_store_dwordx2 v18, v[16:17], s[30:31] sc1
    s_cmp_lt_u32 s48, 4
    s_cbranch_scc1 L_hq
    s_cmp_ge_u32 s49, 14
    s_cbranch_scc1 L_hd
    v_add_u32 v18, 0, v0
    v_add_u32 v19, 160, v0
    s_mov_b32 vcc_lo, 0xff000000
    s_mov_b32 vcc_hi, 0
    v_cndmask_b32 v18, v18, v19, vcc
    v_and_b32 v19, 127, v18
    v_lshrrev_b32 v18, 7, v18
    v_lshl_add_u32 v18, v19, 1, v18
    v_lshlrev_b32 v18, 8, v18
    s_lshl_b32 s72, s49, 2
    s_add_u32 s72, s72, 1179648
    v_add_u32 v18, s72, v18
    global_store_dword v18, v17, s[30:31] sc1
    s_branch L_hd
L_hq:
    s_lshr_b32 s72, s49, 3
    s_lshl_b32 s72, s72, 8
    s_and_b32 s73, s49, 7
    s_lshl_b32 s73, s73, 2
    s_add_u32 s72, s72, s73
    s_add_u32 s72, s72, 1179712
    v_lshlrev_b32 v18, 11, v0
    v_add_u32 v18, s72, v18
    s_mov_b32 exec_hi, 0
    global_store_dword v18, v17, s[30:31] sc1
    s_mov_b64 exec, -1
L_hd:
L_rdone:
    s_nop 1
    s_cmp_ge_u32 s48, 4
    s_cbranch_scc1 L_young
    v_mov_b32 v23, 0
    ds_write_b32 v7, v23 offset:32
    s_branch L_wait
L_young:
    s_mov_b32 s55, 0
Lspin_47:
    ds_read_b32 v19, v7 offset:0
    s_add_u32 s55, s55, 1
    s_cmp_gt_u32 s55, 48000000
    s_cbranch_scc1 L_exit
    s_waitcnt lgkmcnt(0)
    v_readfirstlane_b32 s72, v19
    s_nop 0
    s_cmp_ge_u32 s72, 1
    s_cbranch_scc1 Lsok_48
    s_sleep 1
    s_branch Lspin_47
Lsok_48:
    v_mov_b32 v16, 1
    ds_write_b32 v7, v16 offset:16
    s_cmp_eq_u32 s1, 0
    s_cselect_b64 vcc, 1, 0
    s_nop 4
    s_waitcnt vmcnt(6)
    s_cmp_lt_u32 s59, 8
    s_cbranch_scc1 Lw_49
    s_waitcnt vmcnt(5)
    s_cbranch_vccz Lw_49
    s_waitcnt vmcnt(4)
Lw_49:
    s_add_u32 s57, s56, 0
    buffer_load_dwordx4 v[64:67], v5, s[32:35], s57 offen offset:0 nt
    s_waitcnt vmcnt(6)
    s_cmp_lt_u32 s59, 8
    s_cbranch_scc1 Lw_50
    s_waitcnt vmcnt(5)
    s_cbranch_vccz Lw_50
    s_waitcnt vmcnt(4)
Lw_50:
    buffer_load_dwordx4 v[68:71], v5, s[32:35], s57 offen offset:256 nt
    s_waitcnt vmcnt(6)
    s_cmp_lt_u32 s59, 8
    s_cbranch_scc1 Lw_51
    s_waitcnt vmcnt(5)
    s_cbranch_vccz Lw_51
    s_waitcnt vmcnt(4)
Lw_51:
    s_add_u32 s57, s56, 8192
    buffer_load_dwordx4 v[72:75], v5, s[32:35], s57 offen offset:0 nt
    s_waitcnt vmcnt(6)
    s_cmp_lt_u32 s59, 8
    s_cbranch_scc1 Lw_52
    s_waitcnt vmcnt(5)
    s_cbranch_vccz Lw_52
    s_waitcnt vmcnt(4)
Lw_52:
    buffer_load_dwordx4 v[76:79], v5, s[32:35], s57 offen offset:256 nt
    s_waitcnt vmcnt(6)
    s_cmp_lt_u32 s59, 8
    s_cbranch_scc1 Lw_53
    s_waitcnt vmcnt(5)
    s_cbranch_vccz Lw_53
    s_waitcnt vmcnt(4)
Lw_53:
    s_add_u32 s57, s56, 16384
    buffer_load_dwordx4 v[80:83], v5, s[32:35], s57 offen offset:0 nt
    s_waitcnt vmcnt(6)
    s_cmp_lt_u32 s59, 8
    s_cbranch_scc1 Lw_54
    s_waitcnt vmcnt(5)
    s_cbranch_vccz Lw_54
    s_waitcnt vmcnt(4)
Lw_54:
    buffer_load_dwordx4 v[84:87], v5, s[32:35], s57 offen offset:256 nt
    s_waitcnt vmcnt(6)
    s_cmp_lt_u32 s59, 8
    s_cbranch_scc1 Lw_55
    s_waitcnt vmcnt(5)
    s_cbranch_vccz Lw_55
    s_waitcnt vmcnt(4)
Lw_55:
    s_add_u32 s57, s56, 24576
    buffer_load_dwordx4 v[88:91], v5, s[32:35], s57 offen offset:0 nt
    s_waitcnt vmcnt(6)
    s_cmp_lt_u32 s59, 8
    s_cbranch_scc1 Lw_56
    s_waitcnt vmcnt(5)
    s_cbranch_vccz Lw_56
    s_waitcnt vmcnt(4)
Lw_56:
    buffer_load_dwordx4 v[92:95], v5, s[32:35], s57 offen offset:256 nt
    s_waitcnt vmcnt(6)
    s_cmp_lt_u32 s59, 8
    s_cbranch_scc1 Lw_57
    s_waitcnt vmcnt(5)
    s_cbranch_vccz Lw_57
    s_waitcnt vmcnt(4)
Lw_57:
    s_add_u32 s57, s56, 32768
    buffer_load_dwordx4 v[96:99], v5, s[32:35], s57 offen offset:0 nt
    s_waitcnt vmcnt(6)
    s_cmp_lt_u32 s59, 8
    s_cbranch_scc1 Lw_58
    s_waitcnt vmcnt(5)
    s_cbranch_vccz Lw_58
    s_waitcnt vmcnt(4)
Lw_58:
    buffer_load_dwordx4 v[100:103], v5, s[32:35], s57 offen offset:256 nt
    s_waitcnt vmcnt(6)
    s_cmp_lt_u32 s59, 8
    s_cbranch_scc1 Lw_59
    s_waitcnt vmcnt(5)
    s_cbranch_vccz Lw_59
    s_waitcnt vmcnt(4)
Lw_59:
    s_add_u32 s57, s56, 40960
    buffer_load_dwordx4 v[104:107], v5, s[32:35], s57 offen offset:0 nt
    s_waitcnt vmcnt(6)
    s_cmp_lt_u32 s59, 8
    s_cbranch_scc1 Lw_60
    s_waitcnt vmcnt(5)
    s_cbranch_vccz Lw_60
    s_waitcnt vmcnt(4)
Lw_60:
    buffer_load_dwordx4 v[108:111], v5, s[32:35], s57 offen offset:256 nt
    s_waitcnt vmcnt(6)
    s_cmp_lt_u32 s59, 8
    s_cbranch_scc1 Lw_61
    s_waitcnt vmcnt(5)
    s_cbranch_vccz Lw_61
    s_waitcnt vmcnt(4)
Lw_61:
    s_add_u32 s57, s56, 49152
    buffer_load_dwordx4 v[112:115], v5, s[32:35], s57 offen offset:0 nt
    s_waitcnt vmcnt(6)
    s_cmp_lt_u32 s59, 8
    s_cbranch_scc1 Lw_62
    s_waitcnt vmcnt(5)
    s_cbranch_vccz Lw_62
    s_waitcnt vmcnt(4)
Lw_62:
    buffer_load_dwordx4 v[116:119], v5, s[32:35], s57 offen offset:256 nt
    s_waitcnt vmcnt(6)
    s_cmp_lt_u32 s59, 8
    s_cbranch_scc1 Lw_63
    s_waitcnt vmcnt(5)
    s_cbranch_vccz Lw_63
    s_waitcnt vmcnt(4)
Lw_63:
    s_add_u32 s57, s56, 57344
    buffer_load_dwordx4 v[120:123], v5, s[32:35], s57 offen offset:0 nt
    s_waitcnt vmcnt(6)
    s_cmp_lt_u32 s59, 8
    s_cbranch_scc1 Lw_64
    s_waitcnt vmcnt(5)
    s_cbranch_vccz Lw_64
    s_waitcnt vmcnt(4)
Lw_64:
    buffer_load_dwordx4 v[124:127], v5, s[32:35], s57 offen offset:256 nt
    s_waitcnt vmcnt(6)
    s_cmp_lt_u32 s59, 8
    s_cbranch_scc1 Lw_65
    s_waitcnt vmcnt(5)
    s_cbranch_vccz Lw_65
    s_waitcnt vmcnt(4)
Lw_65:
    s_add_u32 s57, s56, 65536
    buffer_load_dwordx4 v[128:131], v5, s[32:35], s57 offen offset:0 nt
    s_waitcnt vmcnt(6)
    s_cmp_lt_u32 s59, 8
    s_cbranch_scc1 Lw_66
    s_waitcnt vmcnt(5)
    s_cbranch_vccz Lw_66
    s_waitcnt vmcnt(4)
Lw_66:
    buffer_load_dwordx4 v[132:135], v5, s[32:35], s57 offen offset:256 nt
    s_waitcnt vmcnt(6)
    s_cmp_lt_u32 s59, 8
    s_cbranch_scc1 Lw_67
    s_waitcnt vmcnt(5)
    s_cbranch_vccz Lw_67
    s_waitcnt vmcnt(4)
Lw_67:
    s_add_u32 s57, s56, 73728
    buffer_load_dwordx4 v[136:139], v5, s[32:35], s57 offen offset:0 nt
    s_waitcnt vmcnt(6)
    s_cmp_lt_u32 s59, 8
    s_cbranch_scc1 Lw_68
    s_waitcnt vmcnt(5)
    s_cbranch_vccz Lw_68
    s_waitcnt vmcnt(4)
Lw_68:
    buffer_load_dwordx4 v[140:143], v5, s[32:35], s57 offen offset:256 nt
    s_waitcnt vmcnt(6)
    s_cmp_lt_u32 s59, 8
    s_cbranch_scc1 Lw_69
    s_waitcnt vmcnt(5)
    s_cbranch_vccz Lw_69
    s_waitcnt vmcnt(4)
Lw_69:
    s_add_u32 s57, s56, 81920
    buffer_load_dwordx4 v[144:147], v5, s[32:35], s57 offen offset:0 nt
    s_waitcnt vmcnt(6)
    s_cmp_lt_u32 s59, 8
    s_cbranch_scc1 Lw_70
    s_waitcnt vmcnt(5)
    s_cbranch_vccz Lw_70
    s_waitcnt vmcnt(4)
Lw_70:
    buffer_load_dwordx4 v[148:151], v5, s[32:35], s57 offen offset:256 nt
    s_waitcnt vmcnt(6)
    s_cmp_lt_u32 s59, 8
    s_cbranch_scc1 Lw_71
    s_waitcnt vmcnt(5)
    s_cbranch_vccz Lw_71
    s_waitcnt vmcnt(4)
Lw_71:
    s_add_u32 s57, s56, 90112
    buffer_load_dwordx4 v[152:155], v5, s[32:35], s57 offen offset:0 nt
    s_waitcnt vmcnt(6)
    s_cmp_lt_u32 s59, 8
    s_cbranch_scc1 Lw_72
    s_waitcnt vmcnt(5)
    s_cbranch_vccz Lw_72
    s_waitcnt vmcnt(4)
Lw_72:
    buffer_load_dwordx4 v[156:159], v5, s[32:35], s57 offen offset:256 nt
    s_waitcnt vmcnt(6)
    s_cmp_lt_u32 s59, 8
    s_cbranch_scc1 Lw_73
    s_waitcnt vmcnt(5)
    s_cbranch_vccz Lw_73
    s_waitcnt vmcnt(4)
Lw_73:
    s_add_u32 s57, s56, 98304
    buffer_load_dwordx4 v[160:163], v5, s[32:35], s57 offen offset:0 nt
    s_waitcnt vmcnt(6)
    s_cmp_lt_u32 s59, 8
    s_cbranch_scc1 Lw_74
    s_waitcnt vmcnt(5)
    s_cbranch_vccz Lw_74
    s_waitcnt vmcnt(4)
Lw_74:
    buffer_load_dwordx4 v[164:167], v5, s[32:35], s57 offen offset:256 nt
    s_waitcnt vmcnt(6)
    s_cmp_lt_u32 s59, 8
    s_cbranch_scc1 Lw_75
    s_waitcnt vmcnt(5)
    s_cbranch_vccz Lw_75
    s_waitcnt vmcnt(4)
Lw_75:
    s_add_u32 s57, s56, 106496
    buffer_load_dwordx4 v[168:171], v5, s[32:35], s57 offen offset:0 nt
    s_waitcnt vmcnt(6)
    s_cmp_lt_u32 s59, 8
    s_cbranch_scc1 Lw_76
    s_waitcnt vmcnt(5)
    s_cbranch_vccz Lw_76
    s_waitcnt vmcnt(4)
Lw_76:
    buffer_load_dwordx4 v[172:175], v5, s[32:35], s57 offen offset:256 nt
    s_waitcnt vmcnt(6)
    s_cmp_lt_u32 s59, 8
    s_cbranch_scc1 Lw_77
    s_waitcnt vmcnt(5)
    s_cbranch_vccz Lw_77
    s_waitcnt vmcnt(4)
Lw_77:
    s_add_u32 s57, s56, 114688
    buffer_load_dwordx4 v[176:179], v5, s[32:35], s57 offen offset:0 nt
    v_mov_b32 v16, 2
    ds_write_b32 v7, v16 offset:16
    s_waitcnt vmcnt(6)
    s_cmp_lt_u32 s59, 8
    s_cbranch_scc1 Lw_78
    s_waitcnt vmcnt(5)
    s_cbranch_vccz Lw_78
    s_waitcnt vmcnt(4)
Lw_78:
    buffer_load_dwordx4 v[180:183], v5, s[32:35], s57 offen offset:256 nt
    s_waitcnt vmcnt(6)
    s_cmp_lt_u32 s59, 8
    s_cbranch_scc1 Lw_79
    s_waitcnt vmcnt(5)
    s_cbranch_vccz Lw_79
    s_waitcnt vmcnt(4)
Lw_79:
    s_add_u32 s57, s56, 122880
    buffer_load_dwordx4 v[184:187], v5, s[32:35], s57 offen offset:0 nt
    s_waitcnt vmcnt(6)
    s_cmp_lt_u32 s59, 8
    s_cbranch_scc1 Lw_80
    s_waitcnt vmcnt(5)
    s_cbranch_vccz Lw_80
    s_waitcnt vmcnt(4)
Lw_80:
    buffer_load_dwordx4 v[188:191], v5, s[32:35], s57 offen offset:256 nt
L_wait:
    v_mov_b32 v18, 0
    s_lshl_b32 s68, s54, 11
    s_add_u32 s68, s68, 32768
    v_lshlrev_b32 v16, 4, v0
    v_add_u32 v16, s68, v16
    v_lshlrev_b32 v17, 3, v0
    v_add_u32 v17, 13312, v17
    s_mov_b32 s15, 0
    s_mov_b32 s55, 0
    s_cmp_eq_u32 s1, 0
    s_cselect_b64 vcc, 1, 0
    s_nop 4
L_w:
    ds_read_b32 v19, v18 offset:8
    ds_read2_b32 v[20:21], v7 offset0:0 offset1:4
    ds_read_b32 v22, v7 offset:32
    s_add_u32 s55, s55, 1
    s_cmp_gt_u32 s55, 12000000
    s_cbranch_scc1 L_exit
    s_waitcnt lgkmcnt(0)
    v_readfirstlane_b32 s72, v19
    v_readfirstlane_b32 s71, v20
    v_readfirstlane_b32 s70, v21
    v_readfirstlane_b32 s73, v22
    s_cmp_lg_u32 s72, 0
    s_cbranch_scc1 L_qkw
    s_cmp_ge_u32 s15, 4
    s_cbranch_scc1 L_idle
    s_cmp_ge_u32 s48, 4
    s_cbranch_scc1 L_wy
    s_cmp_lg_u32 s70, 1
    s_cbranch_scc1 L_ev
    s_branch L_idle
L_wy:
    s_cmp_ge_u32 s71, 3
    s_cbranch_scc1 L_ev
    s_cmp_lg_u32 s73, 0
    s_cbranch_scc1 L_ev
L_idle:
    s_cmp_eq_u32 s51, 0
    s_cbranch_scc1 L_qpoll
    s_sleep 1
    s_branch L_w
L_qpoll:
    s_load_dwordx8 s[68:75], s[6:7], 64 glc
    s_waitcnt lgkmcnt(0)
    s_xor_b32 s68, s68, s53
    s_xor_b32 s69, s69, s53
    s_xor_b32 s70, s70, s53
    s_xor_b32 s71, s71, s53
    s_xor_b32 s72, s72, s53
    s_xor_b32 s73, s73, s53
    s_xor_b32 s74, s74, s53
    s_xor_b32 s75, s75, s53
    s_or_b64 s[68:69], s[68:69], s[70:71]
    s_or_b64 s[68:69], s[68:69], s[72:73]
    s_or_b64 s[68:69], s[68:69], s[74:75]
    s_and_b32 s70, s55, 63
    s_cselect_b64 s[68:69], s[68:69], 0
    s_cmp_eq_u64 s[68:69], 0
    s_cbranch_scc0 L_w
    s_mov_b32 s70, 0
    global_load_dwordx4 v[24:27], v16, s[30:31] sc1
    global_load_dwordx4 v[28:31], v16, s[30:31] offset:1024 sc1
    global_load_dwordx2 v[32:33], v18, s[30:31] offset:2048 sc1
    s_waitcnt vmcnt(0)
    v_cmp_ne_u32 s[74:75], s53, v33
    s_nop 0
    s_cmp_lg_u64 s[74:75], 0
    s_cbranch_scc1 L_w
    v_cmp_ne_u32 s[74:75], s53, v25
    v_cmp_ne_u32 s[76:77], s53, v27
    v_cmp_ne_u32 s[78:79], s53, v29
    v_cmp_ne_u32 s[80:81], s53, v31
    s_or_b64 s[74:75], s[74:75], s[76:77]
    s_or_b64 s[78:79], s[78:79], s[80:81]
    s_or_b64 s[74:75], s[74:75], s[78:79]
    s_cbranch_scc1 L_w
    ds_write2_b32 v17, v24, v26 offset0:0 offset1:1
    ds_write2_b32 v17, v28, v30 offset0:128 offset1:129
    ds_write_b32 v18, v32 offset:24
    v_mov_b32 v19, 1
    s_waitcnt lgkmcnt(0)
    ds_write_b32 v18, v19 offset:8
    s_branch L_qk
L_ev:
    s_cmp_eq_u32 s15, 1
    s_cbranch_scc1 L_ev1
    s_cmp_eq_u32 s15, 2
    s_cbranch_scc1 L_ev2
    s_cmp_eq_u32 s15, 3
    s_cbranch_scc1 L_ev3
    s_waitcnt vmcnt(6)
    s_cmp_lt_u32 s59, 8
    s_cbranch_scc1 Lw_81
    s_waitcnt vmcnt(5)
    s_cbranch_vccz Lw_81
    s_waitcnt vmcnt(4)
Lw_81:
    s_add_u32 s57, s56, 0
    buffer_load_dwordx4 v[192:195], v6, s[36:39], s57 offen offset:0 nt
    s_waitcnt vmcnt(6)
    s_cmp_lt_u32 s59, 8
    s_cbranch_scc1 Lw_82
    s_waitcnt vmcnt(5)
    s_cbranch_vccz Lw_82
    s_waitcnt vmcnt(4)
Lw_82:
    buffer_load_dwordx4 v[196:199], v6, s[36:39], s57 offen offset:256 nt
    s_waitcnt vmcnt(6)
    s_cmp_lt_u32 s59, 8
    s_cbranch_scc1 Lw_83
    s_waitcnt vmcnt(5)
    s_cbranch_vccz Lw_83
    s_waitcnt vmcnt(4)
Lw_83:
    s_add_u32 s57, s56, 8192
    buffer_load_dwordx4 v[200:203], v6, s[36:39], s57 offen offset:0 nt
    s_waitcnt vmcnt(6)
    s_cmp_lt_u32 s59, 8
    s_cbranch_scc1 Lw_84
    s_waitcnt vmcnt(5)
    s_cbranch_vccz Lw_84
    s_waitcnt vmcnt(4)
Lw_84:
    buffer_load_dwordx4 v[204:207], v6, s[36:39], s57 offen offset:256 nt
    s_mov_b32 s15, 1
    s_branch L_w
L_ev1:
    s_waitcnt vmcnt(6)
    s_cmp_lt_u32 s59, 8
    s_cbranch_scc1 Lw_85
    s_waitcnt vmcnt(5)
    s_cbranch_vccz Lw_85
    s_waitcnt vmcnt(4)
Lw_85:
    s_add_u32 s57, s56, 16384
    buffer_load_dwordx4 v[208:211], v6, s[36:39], s57 offen offset:0 nt
    s_waitcnt vmcnt(6)
    s_cmp_lt_u32 s59, 8
    s_cbranch_scc1 Lw_86
    s_waitcnt vmcnt(5)
    s_cbranch_vccz Lw_86
    s_waitcnt vmcnt(4)
Lw_86:
    buffer_load_dwordx4 v[212:215], v6, s[36:39], s57 offen offset:256 nt
    s_waitcnt vmcnt(6)
    s_cmp_lt_u32 s59, 8
    s_cbranch_scc1 Lw_87
    s_waitcnt vmcnt(5)
    s_cbranch_vccz Lw_87
    s_waitcnt vmcnt(4)
Lw_87:
    s_add_u32 s57, s56, 24576
    buffer_load_dwordx4 v[216:219], v6, s[36:39], s57 offen offset:0 nt
    s_waitcnt vmcnt(6)
    s_cmp_lt_u32 s59, 8
    s_cbranch_scc1 Lw_88
    s_waitcnt vmcnt(5)
    s_cbranch_vccz Lw_88
    s_waitcnt vmcnt(4)
Lw_88:
    buffer_load_dwordx4 v[220:223], v6, s[36:39], s57 offen offset:256 nt
    s_mov_b32 s15, 2
    s_branch L_w
L_ev2:
    s_waitcnt vmcnt(6)
    s_cmp_lt_u32 s59, 8
    s_cbranch_scc1 Lw_89
    s_waitcnt vmcnt(5)
    s_cbranch_vccz Lw_89
    s_waitcnt vmcnt(4)
Lw_89:
    s_add_u32 s57, s56, 32768
    buffer_load_dwordx4 v[224:227], v6, s[36:39], s57 offen offset:0 nt
    s_waitcnt vmcnt(6)
    s_cmp_lt_u32 s59, 8
    s_cbranch_scc1 Lw_90
    s_waitcnt vmcnt(5)
    s_cbranch_vccz Lw_90
    s_waitcnt vmcnt(4)
Lw_90:
    buffer_load_dwordx4 v[228:231], v6, s[36:39], s57 offen offset:256 nt
    s_waitcnt vmcnt(6)
    s_cmp_lt_u32 s59, 8
    s_cbranch_scc1 Lw_91
    s_waitcnt vmcnt(5)
    s_cbranch_vccz Lw_91
    s_waitcnt vmcnt(4)
Lw_91:
    s_add_u32 s57, s56, 40960
    buffer_load_dwordx4 v[232:235], v6, s[36:39], s57 offen offset:0 nt
    s_waitcnt vmcnt(6)
    s_cmp_lt_u32 s59, 8
    s_cbranch_scc1 Lw_92
    s_waitcnt vmcnt(5)
    s_cbranch_vccz Lw_92
    s_waitcnt vmcnt(4)
Lw_92:
    buffer_load_dwordx4 v[236:239], v6, s[36:39], s57 offen offset:256 nt
    s_mov_b32 s15, 3
    s_branch L_w
L_ev3:
    s_waitcnt vmcnt(6)
    s_cmp_lt_u32 s59, 8
    s_cbranch_scc1 Lw_93
    s_waitcnt vmcnt(5)
    s_cbranch_vccz Lw_93
    s_waitcnt vmcnt(4)
Lw_93:
    s_add_u32 s57, s56, 49152
    buffer_load_dwordx4 v[240:243], v6, s[36:39], s57 offen offset:0 nt
    v_mov_b32 v23, 3
    ds_max_u32 v7, v23
    s_waitcnt vmcnt(6)
    s_cmp_lt_u32 s59, 8
    s_cbranch_scc1 Lw_94
    s_waitcnt vmcnt(5)
    s_cbranch_vccz Lw_94
    s_waitcnt vmcnt(4)
Lw_94:
    buffer_load_dwordx4 v[244:247], v6, s[36:39], s57 offen offset:256 nt
    s_waitcnt vmcnt(6)
    s_cmp_lt_u32 s59, 8
    s_cbranch_scc1 Lw_95
    s_waitcnt vmcnt(5)
    s_cbranch_vccz Lw_95
    s_waitcnt vmcnt(4)
Lw_95:
    s_add_u32 s57, s56, 57344
    buffer_load_dwordx4 v[248:251], v6, s[36:39], s57 offen offset:0 nt
    s_waitcnt vmcnt(6)
    s_cmp_lt_u32 s59, 8
    s_cbranch_scc1 Lw_96
    s_waitcnt vmcnt(5)
    s_cbranch_vccz Lw_96
    s_waitcnt vmcnt(4)
Lw_96:
    buffer_load_dwordx4 v[252:255], v6, s[36:39], s57 offen offset:256 nt
    s_mov_b32 s15, 4
    s_branch L_w
L_qkw:
    s_cmp_eq_u32 s15, 0
    s_cbranch_scc1 L_qkw0
    s_cmp_eq_u32 s15, 1
    s_cbranch_scc1 L_qkw1
    s_cmp_eq_u32 s15, 2
    s_cbranch_scc1 L_qkw2
    s_waitcnt vmcnt(12)
    s_branch L_qk
L_qkw2:
    s_waitcnt vmcnt(8)
    s_branch L_qk
L_qkw1:
    s_waitcnt vmcnt(4)
    s_branch L_qk
L_qkw0:
    s_waitcnt vmcnt(0)
L_qk:
    v_lshlrev_b32 v17, 9, v4
    v_lshl_add_u32 v17, v2, 6, v17
    v_and_b32 v16, 3, v0
    v_lshl_add_u32 v17, v16, 4, v17
    ds_read_b128 v[56:59], v17 offset:13312
    ds_read_b128 v[60:63], v17 offset:13568
    ds_read_b32 v19, v18 offset:24
    s_waitcnt lgkmcnt(0)
    v_readfirstlane_b32 s58, v19
    s_nop 0
    s_and_b32 s58, s58, 0x2000
    v_mfma_f32_16x16x32_bf16 v[32:35], v[64:67], v[56:59], 0
    v_mfma_f32_16x16x32_bf16 v[36:39], v[72:75], v[56:59], 0
    v_mfma_f32_16x16x32_bf16 v[32:35], v[68:71], v[60:63], v[32:35]
    v_mfma_f32_16x16x32_bf16 v[36:39], v[76:79], v[60:63], v[36:39]
    v_mfma_f32_16x16x32_bf16 v[40:43], v[80:83], v[56:59], 0
    v_mfma_f32_16x16x32_bf16 v[44:47], v[88:91], v[56:59], 0
    v_mfma_f32_16x16x32_bf16 v[40:43], v[84:87], v[60:63], v[40:43]
    v_mfma_f32_16x16x32_bf16 v[44:47], v[92:95], v[60:63], v[44:47]
    v_mfma_f32_16x16x32_bf16 v[48:51], v[96:99], v[56:59], 0
    s_nop 1
    v_mov_b32_dpp v16, v32 quad_perm:[0,0,0,0] row_mask:0xf bank_mask:0xf
    v_mov_b32_dpp v17, v36 quad_perm:[0,0,0,0] row_mask:0xf bank_mask:0xf
    v_mfma_f32_16x16x32_bf16 v[52:55], v[104:107], v[56:59], 0
    v_add_f32_dpp v16, v33, v16 quad_perm:[1,1,1,1] row_mask:0xf bank_mask:0xf
    v_add_f32_dpp v17, v37, v17 quad_perm:[1,1,1,1] row_mask:0xf bank_mask:0xf
    v_mfma_f32_16x16x32_bf16 v[48:51], v[100:103], v[60:63], v[48:51]
    v_add_f32_dpp v16, v34, v16 quad_perm:[2,2,2,2] row_mask:0xf bank_mask:0xf
    v_add_f32_dpp v17, v38, v17 quad_perm:[2,2,2,2] row_mask:0xf bank_mask:0xf
    v_mfma_f32_16x16x32_bf16 v[52:55], v[108:111], v[60:63], v[52:55]
    v_add_f32_dpp v16, v35, v16 quad_perm:[3,3,3,3] row_mask:0xf bank_mask:0xf
    v_add_f32_dpp v17, v39, v17 quad_perm:[3,3,3,3] row_mask:0xf bank_mask:0xf
    v_mfma_f32_16x16x32_bf16 v[32:35], v[112:115], v[56:59], 0
    v_mov_b32_dpp v18, v40 quad_perm:[0,0,0,0] row_mask:0xf bank_mask:0xf
    v_mov_b32_dpp v19, v44 quad_perm:[0,0,0,0] row_mask:0xf bank_mask:0xf
    v_mfma_f32_16x16x32_bf16 v[36:39], v[120:123], v[56:59], 0
    v_add_f32_dpp v18, v41, v18 quad_perm:[1,1,1,1] row_mask:0xf bank_mask:0xf
    v_add_f32_dpp v19, v45, v19 quad_perm:[1,1,1,1] row_mask:0xf bank_mask:0xf
    v_mfma_f32_16x16x32_bf16 v[32:35], v[116:119], v[60:63], v[32:35]
    v_add_f32_dpp v18, v42, v18 quad_perm:[2,2,2,2] row_mask:0xf bank_mask:0xf
    v_add_f32_dpp v19, v46, v19 quad_perm:[2,2,2,2] row_mask:0xf bank_mask:0xf
    v_mfma_f32_16x16x32_bf16 v[36:39], v[124:127], v[60:63], v[36:39]
    v_add_f32_dpp v18, v43, v18 quad_perm:[3,3,3,3] row_mask:0xf bank_mask:0xf
    v_add_f32_dpp v19, v47, v19 quad_perm:[3,3,3,3] row_mask:0xf bank_mask:0xf
    v_mfma_f32_16x16x32_bf16 v[40:43], v[128:131], v[56:59], 0
    v_mov_b32_dpp v20, v48 quad_perm:[0,0,0,0] row_mask:0xf bank_mask:0xf
    v_mov_b32_dpp v21, v52 quad_perm:[0,0,0,0] row_mask:0xf bank_mask:0xf
    v_mfma_f32_16x16x32_bf16 v[44:47], v[136:139], v[56:59], 0
    v_add_f32_dpp v20, v49, v20 quad_perm:[1,1,1,1] row_mask:0xf bank_mask:0xf
    v_add_f32_dpp v21, v53, v21 quad_perm:[1,1,1,1] row_mask:0xf bank_mask:0xf
    v_mfma_f32_16x16x32_bf16 v[40:43], v[132:135], v[60:63], v[40:43]
    v_add_f32_dpp v20, v50, v20 quad_perm:[2,2,2,2] row_mask:0xf bank_mask:0xf
    v_add_f32_dpp v21, v54, v21 quad_perm:[2,2,2,2] row_mask:0xf bank_mask:0xf
    v_mfma_f32_16x16x32_bf16 v[44:47], v[140:143], v[60:63], v[44:47]
    v_add_f32_dpp v20, v51, v20 quad_perm:[3,3,3,3] row_mask:0xf bank_mask:0xf
    v_add_f32_dpp v21, v55, v21 quad_perm:[3,3,3,3] row_mask:0xf bank_mask:0xf
    v_mfma_f32_16x16x32_bf16 v[48:51], v[144:147], v[56:59], 0
    v_mov_b32_dpp v22, v32 quad_perm:[0,0,0,0] row_mask:0xf bank_mask:0xf
    v_mov_b32_dpp v23, v36 quad_perm:[0,0,0,0] row_mask:0xf bank_mask:0xf
    v_mfma_f32_16x16x32_bf16 v[52:55], v[152:155], v[56:59], 0
    v_add_f32_dpp v22, v33, v22 quad_perm:[1,1,1,1] row_mask:0xf bank_mask:0xf
    v_add_f32_dpp v23, v37, v23 quad_perm:[1,1,1,1] row_mask:0xf bank_mask:0xf
    v_mfma_f32_16x16x32_bf16 v[48:51], v[148:151], v[60:63], v[48:51]
    v_add_f32_dpp v22, v34, v22 quad_perm:[2,2,2,2] row_mask:0xf bank_mask:0xf
    v_add_f32_dpp v23, v38, v23 quad_perm:[2,2,2,2] row_mask:0xf bank_mask:0xf
    v_mfma_f32_16x16x32_bf16 v[52:55], v[156:159], v[60:63], v[52:55]
    v_add_f32_dpp v22, v35, v22 quad_perm:[3,3,3,3] row_mask:0xf bank_mask:0xf
    v_add_f32_dpp v23, v39, v23 quad_perm:[3,3,3,3] row_mask:0xf bank_mask:0xf
    v_mfma_f32_16x16x32_bf16 v[32:35], v[160:163], v[56:59], 0
    v_mov_b32_dpp v24, v40 quad_perm:[0,0,0,0] row_mask:0xf bank_mask:0xf
    v_mov_b32_dpp v25, v44 quad_perm:[0,0,0,0] row_mask:0xf bank_mask:0xf
    v_mfma_f32_16x16x32_bf16 v[36:39], v[168:171], v[56:59], 0
    v_add_f32_dpp v24, v41, v24 quad_perm:[1,1,1,1] row_mask:0xf bank_mask:0xf
    v_add_f32_dpp v25, v45, v25 quad_perm:[1,1,1,1] row_mask:0xf bank_mask:0xf
    v_mfma_f32_16x16x32_bf16 v[32:35], v[164:167], v[60:63], v[32:35]
    v_add_f32_dpp v24, v42, v24 quad_perm:[2,2,2,2] row_mask:0xf bank_mask:0xf
    v_add_f32_dpp v25, v46, v25 quad_perm:[2,2,2,2] row_mask:0xf bank_mask:0xf
    v_mfma_f32_16x16x32_bf16 v[36:39], v[172:175], v[60:63], v[36:39]
    v_add_f32_dpp v24, v43, v24 quad_perm:[3,3,3,3] row_mask:0xf bank_mask:0xf
    v_add_f32_dpp v25, v47, v25 quad_perm:[3,3,3,3] row_mask:0xf bank_mask:0xf
    v_mfma_f32_16x16x32_bf16 v[40:43], v[176:179], v[56:59], 0
    v_mov_b32_dpp v26, v48 quad_perm:[0,0,0,0] row_mask:0xf bank_mask:0xf
    v_mov_b32_dpp v27, v52 quad_perm:[0,0,0,0] row_mask:0xf bank_mask:0xf
    v_mfma_f32_16x16x32_bf16 v[44:47], v[184:187], v[56:59], 0
    v_add_f32_dpp v26, v49, v26 quad_perm:[1,1,1,1] row_mask:0xf bank_mask:0xf
    v_add_f32_dpp v27, v53, v27 quad_perm:[1,1,1,1] row_mask:0xf bank_mask:0xf
    v_mfma_f32_16x16x32_bf16 v[40:43], v[180:183], v[60:63], v[40:43]
    v_add_f32_dpp v26, v50, v26 quad_perm:[2,2,2,2] row_mask:0xf bank_mask:0xf
    v_add_f32_dpp v27, v54, v27 quad_perm:[2,2,2,2] row_mask:0xf bank_mask:0xf
    v_mfma_f32_16x16x32_bf16 v[44:47], v[188:191], v[60:63], v[44:47]
    v_add_f32_dpp v26, v51, v26 quad_perm:[3,3,3,3] row_mask:0xf bank_mask:0xf
    v_add_f32_dpp v27, v55, v27 quad_perm:[3,3,3,3] row_mask:0xf bank_mask:0xf
    v_mov_b32_dpp v28, v32 quad_perm:[0,0,0,0] row_mask:0xf bank_mask:0xf
    v_mov_b32_dpp v29, v36 quad_perm:[0,0,0,0] row_mask:0xf bank_mask:0xf
    s_nop 0
    v_add_f32_dpp v28, v33, v28 quad_perm:[1,1,1,1] row_mask:0xf bank_mask:0xf
    v_add_f32_dpp v29, v37, v29 quad_perm:[1,1,1,1] row_mask:0xf bank_mask:0xf
    s_nop 0
    v_add_f32_dpp v28, v34, v28 quad_perm:[2,2,2,2] row_mask:0xf bank_mask:0xf
    v_add_f32_dpp v29, v38, v29 quad_perm:[2,2,2,2] row_mask:0xf bank_mask:0xf
    s_nop 0
    v_add_f32_dpp v28, v35, v28 quad_perm:[3,3,3,3] row_mask:0xf bank_mask:0xf
    v_add_f32_dpp v29, v39, v29 quad_perm:[3,3,3,3] row_mask:0xf bank_mask:0xf
    v_mov_b32_dpp v30, v40 quad_perm:[0,0,0,0] row_mask:0xf bank_mask:0xf
    v_mov_b32_dpp v31, v44 quad_perm:[0,0,0,0] row_mask:0xf bank_mask:0xf
    s_nop 0
    v_add_f32_dpp v30, v41, v30 quad_perm:[1,1,1,1] row_mask:0xf bank_mask:0xf
    v_add_f32_dpp v31, v45, v31 quad_perm:[1,1,1,1] row_mask:0xf bank_mask:0xf
    s_nop 0
    v_add_f32_dpp v30, v42, v30 quad_perm:[2,2,2,2] row_mask:0xf bank_mask:0xf
    v_add_f32_dpp v31, v46, v31 quad_perm:[2,2,2,2] row_mask:0xf bank_mask:0xf
    s_nop 0
    v_add_f32_dpp v30, v43, v30 quad_perm:[3,3,3,3] row_mask:0xf bank_mask:0xf
    v_add_f32_dpp v31, v47, v31 quad_perm:[3,3,3,3] row_mask:0xf bank_mask:0xf
    s_cmp_lt_u32 s48, 4
    s_cbranch_scc1 L_gold
L_stats:
    v_cvt_pk_bf16_f32 v17, v16, v17
    v_lshlrev_b32 v16, 16, v17
    v_and_b32 v17, s14, v17
    v_cvt_pk_bf16_f32 v19, v18, v19
    v_lshlrev_b32 v18, 16, v19
    v_and_b32 v19, s14, v19
    v_cvt_pk_bf16_f32 v21, v20, v21
    v_lshlrev_b32 v20, 16, v21
    v_and_b32 v21, s14, v21
    v_cvt_pk_bf16_f32 v23, v22, v23
    v_lshlrev_b32 v22, 16, v23
    v_and_b32 v23, s14, v23
    v_cvt_pk_bf16_f32 v25, v24, v25
    v_lshlrev_b32 v24, 16, v25
    v_and_b32 v25, s14, v25
    v_cvt_pk_bf16_f32 v27, v26, v27
    v_lshlrev_b32 v26, 16, v27
    v_and_b32 v27, s14, v27
    v_cvt_pk_bf16_f32 v29, v28, v29
    v_lshlrev_b32 v28, 16, v29
    v_and_b32 v29, s14, v29
    v_cvt_pk_bf16_f32 v31, v30, v31
    v_lshlrev_b32 v30, 16, v31
    v_and_b32 v31, s14, v31
    v_max3_f32 v32, v16, v17, v18
    v_max3_f32 v32, v32, v19, v20
    v_max3_f32 v32, v32, v21, v22
    v_max3_f32 v32, v32, v23, v24
    v_max3_f32 v32, v32, v25, v26
    v_max3_f32 v32, v32, v27, v28
    v_max3_f32 v32, v32, v29, v30
    v_max_f32 v32, v32, v31
    v_mov_b32 v34, v32
    s_nop 1
    v_permlane16_swap_b32 v32, v34
    v_max_f32 v32, v32, v34
    v_mov_b32 v34, v32
    s_nop 1
    v_permlane32_swap_b32 v32, v34
    v_max_f32 v32, v32, v34
    v_sub_f32 v16, v16, v32
    v_sub_f32 v17, v17, v32
    v_sub_f32 v18, v18, v32
    v_sub_f32 v19, v19, v32
    v_sub_f32 v20, v20, v32
    v_sub_f32 v21, v21, v32
    v_sub_f32 v22, v22, v32
    v_sub_f32 v23, v23, v32
    v_sub_f32 v24, v24, v32
    v_sub_f32 v25, v25, v32
    v_sub_f32 v26, v26, v32
    v_sub_f32 v27, v27, v32
    v_sub_f32 v28, v28, v32
    v_sub_f32 v29, v29, v32
    v_sub_f32 v30, v30, v32
    v_sub_f32 v31, v31, v32
    v_mul_f32 v16, s3, v16
    v_mul_f32 v17, s3, v17
    v_mul_f32 v18, s3, v18
    v_mul_f32 v19, s3, v19
    v_mul_f32 v20, s3, v20
    v_mul_f32 v21, s3, v21
    v_mul_f32 v22, s3, v22
    v_mul_f32 v23, s3, v23
    v_mul_f32 v24, s3, v24
    v_mul_f32 v25, s3, v25
    v_mul_f32 v26, s3, v26
    v_mul_f32 v27, s3, v27
    v_mul_f32 v28, s3, v28
    v_mul_f32 v29, s3, v29
    v_mul_f32 v30, s3, v30
    v_mul_f32 v31, s3, v31
    v_exp_f32 v16, v16
    v_exp_f32 v17, v17
    v_exp_f32 v18, v18
    v_exp_f32 v19, v19
    v_exp_f32 v20, v20
    v_exp_f32 v21, v21
    v_exp_f32 v22, v22
    v_exp_f32 v23, v23
    v_exp_f32 v24, v24
    v_exp_f32 v25, v25
    v_exp_f32 v26, v26
    v_exp_f32 v27, v27
    v_exp_f32 v28, v28
    v_exp_f32 v29, v29
    v_exp_f32 v30, v30
    v_exp_f32 v31, v31
    v_add_f32 v33, v16, v17
    v_add_f32 v34, v18, v19
    v_add_f32 v33, v33, v20
    v_add_f32 v34, v34, v21
    v_add_f32 v33, v33, v22
    v_add_f32 v34, v34, v23
    v_add_f32 v33, v33, v24
    v_add_f32 v34, v34, v25
    v_add_f32 v33, v33, v26
    v_add_f32 v34, v34, v27
    v_add_f32 v33, v33, v28
    v_add_f32 v34, v34, v29
    v_add_f32 v33, v33, v30
    v_add_f32 v34, v34, v31
    v_add_f32 v33, v33, v34
    v_mov_b32 v34, v33
    s_nop 1
    v_permlane16_swap_b32 v33, v34
    v_add_f32 v33, v33, v34
    v_mov_b32 v34, v33
    s_nop 1
    v_permlane32_swap_b32 v33, v34
    v_add_f32 v33, v33, v34
    s_lshl_b32 s68, s48, 4
    v_add_u32 v34, s68, v0
    v_mov_b32 v35, 0
    v_mov_b32 v36, 1
    s_mov_b64 exec, 0x101
    ds_write_b64 v34, v[32:33] offset:96
    s_mov_b64 exec, 1
    s_waitcnt lgkmcnt(0)
    ds_add_rtn_u32 v37, v35, v36 offset:4
    s_waitcnt lgkmcnt(0)
    v_readfirstlane_b32 s68, v37
    s_mov_b64 exec, -1
    s_cmp_lg_u32 s68, 7
    s_cbranch_scc1 L_nostat
    v_lshlrev_b32 v34, 4, v3
    v_lshl_add_u32 v34, v4, 3, v34
    ds_read_b64 v[36:37], v34 offset:96
    s_waitcnt lgkmcnt(0)
    v_mov_b32 v40, v36
    s_nop 1
    v_max_f32_dpp v40, v40, v40 quad_perm:[1,0,3,2] row_mask:0xf bank_mask:0xf
    s_nop 1
    v_max_f32_dpp v40, v40, v40 quad_perm:[2,3,0,1] row_mask:0xf bank_mask:0xf
    s_nop 1
    v_max_f32_dpp v40, v40, v40 row_half_mirror row_mask:0xf bank_mask:0xf
    v_sub_f32 v36, v36, v40
    v_mul_f32 v36, s3, v36
    v_exp_f32 v36, v36
    s_nop 0
    v_mul_f32 v42, v36, v37
    s_nop 1
    v_add_f32_dpp v42, v42, v42 quad_perm:[1,0,3,2] row_mask:0xf bank_mask:0xf
    s_nop 1
    v_add_f32_dpp v42, v42, v42 quad_perm:[2,3,0,1] row_mask:0xf bank_mask:0xf
    s_nop 1
    v_add_f32_dpp v42, v42, v42 row_half_mirror row_mask:0xf bank_mask:0xf
    v_mov_b32 v41, s53
    v_mov_b32 v43, s53
    s_lshl_b32 s68, s54, 11
    s_lshl_b32 s69, s52, 7
    s_add_u32 s68, s68, s69
    s_add_u32 s68, s68, 65536
    v_lshlrev_b32 v34, 4, v4
    v_add_u32 v34, s68, v34
    v_lshlrev_b32 v37, 2, v4
    s_mov_b64 exec, 0x101
    ds_write_b32 v37, v40 offset:224
    global_store_dwordx4 v34, v[40:43], s[30:31] sc1
    s_mov_b64 exec, 1
    v_mov_b32 v36, 1
    ds_write_b32 v35, v36 offset:12
    s_mov_b64 exec, -1
    s_nop 2
L_nostat:
    s_cmp_lt_u32 s48, 4
    s_cselect_b32 s68, s15, 99
    s_cmp_eq_u32 s68, 0
    s_cbranch_scc1 L_ms0
    s_cmp_eq_u32 s68, 1
    s_cbranch_scc1 L_ms1
    s_cmp_eq_u32 s68, 2
    s_cbranch_scc1 L_ms2
    s_cmp_eq_u32 s68, 3
    s_cbranch_scc1 L_ms3
    s_cmp_eq_u32 s68, 4
    s_cbranch_scc1 L_ms4
    s_mov_b32 s55, 0
Lspin_97:
    ds_read_b32 v34, v7 offset:0
    s_add_u32 s55, s55, 1
    s_cmp_gt_u32 s55, 48000000
    s_cbranch_scc1 L_exit
    s_waitcnt lgkmcnt(0)
    v_readfirstlane_b32 s72, v34
    s_nop 0
    s_cmp_ge_u32 s72, 4
    s_cbranch_scc1 Lsok_98
    s_sleep 1
    s_branch Lspin_97
Lsok_98:
    s_mov_b32 s73, 5
    s_branch L_gv
L_gold:
    s_mov_b32 s55, 0
Lspin_99:
    ds_read_b32 v34, v7 offset:16
    s_add_u32 s55, s55, 1
    s_cmp_gt_u32 s55, 48000000
    s_cbranch_scc1 L_exit
    s_waitcnt lgkmcnt(0)
    v_readfirstlane_b32 s72, v34
    s_nop 0
    s_cmp_ge_u32 s72, 2
    s_cbranch_scc1 Lsok_100
    s_sleep 1
    s_branch Lspin_99
Lsok_100:
    s_mov_b32 s73, 4
L_gv:
    s_mov_b32 s61, s73
    s_cmp_lt_u32 s48, 4
    s_cselect_b32 s63, s15, 99
    v_mov_b32 v35, s73
    s_lshr_b32 s72, s48, 2
    s_and_b32 s72, s72, s1
    s_cmp_eq_u32 s72, 0
    s_cselect_b64 vcc, 1, 0
    s_nop 4
    s_cmp_eq_u32 s15, 1
    s_cbranch_scc1 L_v1
    s_cmp_eq_u32 s15, 2
    s_cbranch_scc1 L_v2
    s_cmp_eq_u32 s15, 3
    s_cbranch_scc1 L_v3
    s_cmp_eq_u32 s15, 4
    s_cbranch_scc1 L_v4
    s_waitcnt vmcnt(19)
    s_cbranch_vccz Lw_101
    s_waitcnt vmcnt(6)
Lw_101:
    s_add_u32 s57, s56, 0
    buffer_load_dwordx4 v[192:195], v6, s[36:39], s57 offen offset:0 nt
    s_waitcnt vmcnt(19)
    s_cbranch_vccz Lw_102
    s_waitcnt vmcnt(6)
Lw_102:
    buffer_load_dwordx4 v[196:199], v6, s[36:39], s57 offen offset:256 nt
    s_waitcnt vmcnt(19)
    s_cbranch_vccz Lw_103
    s_waitcnt vmcnt(6)
Lw_103:
    s_add_u32 s57, s56, 8192
    buffer_load_dwordx4 v[200:203], v6, s[36:39], s57 offen offset:0 nt
    s_waitcnt vmcnt(19)
    s_cbranch_vccz Lw_104
    s_waitcnt vmcnt(6)
Lw_104:
    buffer_load_dwordx4 v[204:207], v6, s[36:39], s57 offen offset:256 nt
L_v1:
    s_waitcnt vmcnt(19)
    s_cbranch_vccz Lw_105
    s_waitcnt vmcnt(6)
Lw_105:
    s_add_u32 s57, s56, 16384
    buffer_load_dwordx4 v[208:211], v6, s[36:39], s57 offen offset:0 nt
    s_waitcnt vmcnt(19)
    s_cbranch_vccz Lw_106
    s_waitcnt vmcnt(6)
Lw_106:
    buffer_load_dwordx4 v[212:215], v6, s[36:39], s57 offen offset:256 nt
    s_waitcnt vmcnt(19)
    s_cbranch_vccz Lw_107
    s_waitcnt vmcnt(6)
Lw_107:
    s_add_u32 s57, s56, 24576
    buffer_load_dwordx4 v[216:219], v6, s[36:39], s57 offen offset:0 nt
    s_waitcnt vmcnt(19)
    s_cbranch_vccz Lw_108
    s_waitcnt vmcnt(6)
Lw_108:
    buffer_load_dwordx4 v[220:223], v6, s[36:39], s57 offen offset:256 nt
    s_cmp_eq_u32 s63, 0
    s_cbranch_scc1 L_stats
L_ms0:
L_v2:
    s_waitcnt vmcnt(19)
    s_cbranch_vccz Lw_109
    s_waitcnt vmcnt(6)
Lw_109:
    s_add_u32 s57, s56, 32768
    buffer_load_dwordx4 v[224:227], v6, s[36:39], s57 offen offset:0 nt
    s_waitcnt vmcnt(19)
    s_cbranch_vccz Lw_110
    s_waitcnt vmcnt(6)
Lw_110:
    buffer_load_dwordx4 v[228:231], v6, s[36:39], s57 offen offset:256 nt
    s_waitcnt vmcnt(19)
    s_cbranch_vccz Lw_111
    s_waitcnt vmcnt(6)
Lw_111:
    s_add_u32 s57, s56, 40960
    buffer_load_dwordx4 v[232:235], v6, s[36:39], s57 offen offset:0 nt
    s_waitcnt vmcnt(19)
    s_cbranch_vccz Lw_112
    s_waitcnt vmcnt(6)
Lw_112:
    buffer_load_dwordx4 v[236:239], v6, s[36:39], s57 offen offset:256 nt
    s_cmp_eq_u32 s63, 1
    s_cbranch_scc1 L_stats
L_ms1:
L_v3:
    s_waitcnt vmcnt(19)
    s_cbranch_vccz Lw_113
    s_waitcnt vmcnt(6)
Lw_113:
    s_add_u32 s57, s56, 49152
    buffer_load_dwordx4 v[240:243], v6, s[36:39], s57 offen offset:0 nt
    s_waitcnt vmcnt(19)
    s_cbranch_vccz Lw_114
    s_waitcnt vmcnt(6)
Lw_114:
    buffer_load_dwordx4 v[244:247], v6, s[36:39], s57 offen offset:256 nt
    s_waitcnt vmcnt(19)
    s_cbranch_vccz Lw_115
    s_waitcnt vmcnt(6)
Lw_115:
    s_add_u32 s57, s56, 57344
    buffer_load_dwordx4 v[248:251], v6, s[36:39], s57 offen offset:0 nt
    s_waitcnt vmcnt(19)
    s_cbranch_vccz Lw_116
    s_waitcnt vmcnt(6)
Lw_116:
    buffer_load_dwordx4 v[252:255], v6, s[36:39], s57 offen offset:256 nt
    s_cmp_eq_u32 s63, 2
    s_cbranch_scc1 L_stats
L_ms2:
L_v4:
    s_waitcnt vmcnt(19)
    s_cbranch_vccz Lw_117
    s_waitcnt vmcnt(6)
Lw_117:
    s_add_u32 s57, s56, 65536
    buffer_load_dwordx4 v[64:67], v6, s[36:39], s57 offen offset:0 nt
    s_waitcnt vmcnt(19)
    s_cbranch_vccz Lw_118
    s_waitcnt vmcnt(6)
Lw_118:
    buffer_load_dwordx4 v[68:71], v6, s[36:39], s57 offen offset:256 nt
    s_waitcnt vmcnt(19)
    s_cbranch_vccz Lw_119
    s_waitcnt vmcnt(6)
Lw_119:
    s_add_u32 s57, s56, 73728
    buffer_load_dwordx4 v[72:75], v6, s[36:39], s57 offen offset:0 nt
    s_waitcnt vmcnt(19)
    s_cbranch_vccz Lw_120
    s_waitcnt vmcnt(6)
Lw_120:
    buffer_load_dwordx4 v[76:79], v6, s[36:39], s57 offen offset:256 nt
    s_cmp_eq_u32 s63, 3
    s_cbranch_scc1 L_stats
L_ms3:
    s_waitcnt vmcnt(19)
    s_cbranch_vccz Lw_121
    s_waitcnt vmcnt(6)
Lw_121:
    s_add_u32 s57, s56, 81920
    buffer_load_dwordx4 v[80:83], v6, s[36:39], s57 offen offset:0 nt
    s_waitcnt vmcnt(19)
    s_cbranch_vccz Lw_122
    s_waitcnt vmcnt(6)
Lw_122:
    buffer_load_dwordx4 v[84:87], v6, s[36:39], s57 offen offset:256 nt
    s_cmp_lt_u32 s48, 4
    s_cselect_b64 vcc, 1, 0
    s_nop 4
    s_waitcnt vmcnt(19)
    s_cbranch_vccz Lw_123
    s_waitcnt vmcnt(6)
Lw_123:
    s_add_u32 s57, s56, 90112
    buffer_load_dwordx4 v[88:91], v6, s[36:39], s57 offen offset:0 nt
    s_waitcnt vmcnt(19)
    s_cbranch_vccz Lw_124
    s_waitcnt vmcnt(6)
Lw_124:
    buffer_load_dwordx4 v[92:95], v6, s[36:39], s57 offen offset:256 nt
    s_cmp_eq_u32 s63, 4
    s_cbranch_scc1 L_stats
L_ms4:
    s_waitcnt vmcnt(19)
    s_cbranch_vccz Lw_125
    s_waitcnt vmcnt(6)
Lw_125:
    s_add_u32 s57, s56, 98304
    buffer_load_dwordx4 v[96:99], v6, s[36:39], s57 offen offset:0 nt
    s_waitcnt vmcnt(19)
    s_cbranch_vccz Lw_126
    s_waitcnt vmcnt(6)
Lw_126:
    buffer_load_dwordx4 v[100:103], v6, s[36:39], s57 offen offset:256 nt
    s_waitcnt vmcnt(19)
    s_cbranch_vccz Lw_127
    s_waitcnt vmcnt(6)
Lw_127:
    s_add_u32 s57, s56, 106496
    buffer_load_dwordx4 v[104:107], v6, s[36:39], s57 offen offset:0 nt
    s_waitcnt vmcnt(19)
    s_cbranch_vccz Lw_128
    s_waitcnt vmcnt(6)
Lw_128:
    buffer_load_dwordx4 v[108:111], v6, s[36:39], s57 offen offset:256 nt
    s_waitcnt vmcnt(19)
    s_cbranch_vccz Lw_129
    s_waitcnt vmcnt(6)
Lw_129:
    s_add_u32 s57, s56, 114688
    buffer_load_dwordx4 v[112:115], v6, s[36:39], s57 offen offset:0 nt
    v_mov_b32 v35, s61
    ds_max_u32 v7, v35
    s_waitcnt vmcnt(19)
    s_cbranch_vccz Lw_130
    s_waitcnt vmcnt(6)
Lw_130:
    buffer_load_dwordx4 v[116:119], v6, s[36:39], s57 offen offset:256 nt
    s_waitcnt vmcnt(19)
    s_cbranch_vccz Lw_131
    s_waitcnt vmcnt(6)
Lw_131:
    s_add_u32 s57, s56, 122880
    buffer_load_dwordx4 v[120:123], v6, s[36:39], s57 offen offset:0 nt
    s_waitcnt vmcnt(19)
    s_cbranch_vccz Lw_132
    s_waitcnt vmcnt(6)
Lw_132:
    buffer_load_dwordx4 v[124:127], v6, s[36:39], s57 offen offset:256 nt
    s_cmp_lt_u32 s48, 4
    s_cbranch_scc1 L_st1
    v_mov_b32 v46, 0
    v_mov_b32 v47, 1
    s_mov_b64 exec, 1
    ds_add_u32 v46, v47 offset:20
    s_mov_b64 exec, -1
L_st1:
    v_mov_b32 v46, 0
    v_lshlrev_b32 v47, 2, v4
    s_mov_b32 s55, 0
L_st2:
    ds_read_b32 v37, v46 offset:12
    ds_read_b32 v44, v47 offset:224
    s_add_u32 s55, s55, 1
    s_cmp_gt_u32 s55, 24000000
    s_cbranch_scc1 L_exit
    s_waitcnt lgkmcnt(0)
    v_readfirstlane_b32 s71, v37
    s_nop 0
    s_cmp_eq_u32 s71, 0
    s_cbranch_scc1 L_st2
    v_sub_f32 v44, v32, v44
    v_mul_f32 v44, s3, v44
    v_exp_f32 v44, v44
    s_nop 0
    v_mul_f32 v16, v16, v44
    v_mul_f32 v17, v17, v44
    v_mul_f32 v18, v18, v44
    v_mul_f32 v19, v19, v44
    v_mul_f32 v20, v20, v44
    v_mul_f32 v21, v21, v44
    v_mul_f32 v22, v22, v44
    v_mul_f32 v23, v23, v44
    v_mul_f32 v24, v24, v44
    v_mul_f32 v25, v25, v44
    v_mul_f32 v26, v26, v44
    v_mul_f32 v27, v27, v44
    v_mul_f32 v28, v28, v44
    v_mul_f32 v29, v29, v44
    v_mul_f32 v30, v30, v44
    v_mul_f32 v31, v31, v44
    v_cvt_pk_bf16_f32 v16, v16, v17
    v_cvt_pk_bf16_f32 v17, v18, v19
    v_cvt_pk_bf16_f32 v18, v20, v21
    v_cvt_pk_bf16_f32 v19, v22, v23
    v_cvt_pk_bf16_f32 v20, v24, v25
    v_cvt_pk_bf16_f32 v21, v26, v27
    v_cvt_pk_bf16_f32 v22, v28, v29
    v_cvt_pk_bf16_f32 v23, v30, v31
L_pv:
    v_perm_b32 v32, v16, v16, v8
    v_perm_b32 v33, v16, v16, v9
    v_perm_b32 v34, v16, v16, v10
    v_perm_b32 v35, v16, v16, v11
    v_perm_b32 v36, v16, v16, v12
    v_perm_b32 v37, v16, v16, v13
    v_perm_b32 v38, v16, v16, v14
    v_perm_b32 v39, v16, v16, v15
    v_perm_b32 v40, v17, v17, v8
    v_perm_b32 v41, v17, v17, v9
    v_perm_b32 v42, v17, v17, v10
    v_perm_b32 v43, v17, v17, v11
    v_perm_b32 v44, v17, v17, v12
    v_perm_b32 v45, v17, v17, v13
    v_perm_b32 v46, v17, v17, v14
    v_perm_b32 v47, v17, v17, v15
    s_waitcnt vmcnt(24)
    v_mfma_f32_16x16x32_bf16 v[24:27], v[192:195], v[32:35], 0
    v_mfma_f32_16x16x32_bf16 v[28:31], v[196:199], v[32:35], 0
    v_mfma_f32_16x16x32_bf16 v[24:27], v[200:203], v[36:39], v[24:27]
    v_mfma_f32_16x16x32_bf16 v[28:31], v[204:207], v[36:39], v[28:31]
    v_mfma_f32_16x16x32_bf16 v[24:27], v[208:211], v[40:43], v[24:27]
    v_mfma_f32_16x16x32_bf16 v[28:31], v[212:215], v[40:43], v[28:31]
    v_mfma_f32_16x16x32_bf16 v[24:27], v[216:219], v[44:47], v[24:27]
    v_mfma_f32_16x16x32_bf16 v[28:31], v[220:223], v[44:47], v[28:31]
    s_lshl_b32 s68, s48, 11
    v_lshlrev_b32 v192, 4, v0
    v_add_u32 v192, s68, v192
    s_lshl_b32 s68, s51, 9
    v_lshrrev_b32 v193, 1, v2
    v_lshlrev_b32 v193, 8, v193
    v_lshl_add_u32 v193, v1, 4, v193
    v_and_b32 v194, 1, v2
    v_lshl_add_u32 v193, v194, 3, v193
    v_add_u32 v193, s68, v193
    s_sub_u32 s69, s2, 0
    s_and_b32 s68, s69, 3
    s_lshl_b32 s68, s68, 2
    s_add_u32 s68, s68, s51
    s_lshl_b32 s68, s68, 16
    s_lshl_b32 s69, s69, 11
    s_xor_b32 s69, s69, s58
    s_and_b32 s69, s69, 0x2000
    s_add_u32 s68, s68, s69
    s_lshr_b32 s69, s2, 3
    s_lshl_b32 s69, s69, 7
    s_add_u32 s68, s68, s69
    s_add_u32 s68, s68, 2097152
    v_lshlrev_b32 v194, 14, v2
    v_lshl_add_u32 v194, v4, 12, v194
    v_lshl_add_u32 v194, v3, 4, v194
    v_add_u32 v194, s68, v194
    v_mov_b32 v197, s53
    v_mov_b32 v199, s53
    v_mov_b32 v200, 0
    v_mov_b32 v201, 1
    v_perm_b32 v48, v18, v18, v8
    v_perm_b32 v49, v18, v18, v9
    v_perm_b32 v50, v18, v18, v10
    v_perm_b32 v51, v18, v18, v11
    v_perm_b32 v52, v18, v18, v12
    v_perm_b32 v53, v18, v18, v13
    v_perm_b32 v54, v18, v18, v14
    v_perm_b32 v55, v18, v18, v15
    v_perm_b32 v56, v19, v19, v8
    v_perm_b32 v57, v19, v19, v9
    v_perm_b32 v58, v19, v19, v10
    v_perm_b32 v59, v19, v19, v11
    v_perm_b32 v60, v19, v19, v12
    v_perm_b32 v61, v19, v19, v13
    v_perm_b32 v62, v19, v19, v14
    v_perm_b32 v63, v19, v19, v15
    s_waitcnt vmcnt(16)
    v_mfma_f32_16x16x32_bf16 v[24:27], v[224:227], v[48:51], v[24:27]
    v_mfma_f32_16x16x32_bf16 v[28:31], v[228:231], v[48:51], v[28:31]
    v_mfma_f32_16x16x32_bf16 v[24:27], v[232:235], v[52:55], v[24:27]
    v_mfma_f32_16x16x32_bf16 v[28:31], v[236:239], v[52:55], v[28:31]
    v_mfma_f32_16x16x32_bf16 v[24:27], v[240:243], v[56:59], v[24:27]
    v_mfma_f32_16x16x32_bf16 v[28:31], v[244:247], v[56:59], v[28:31]
    v_mfma_f32_16x16x32_bf16 v[24:27], v[248:251], v[60:63], v[24:27]
    v_mfma_f32_16x16x32_bf16 v[28:31], v[252:255], v[60:63], v[28:31]
    v_perm_b32 v32, v20, v20, v8
    v_perm_b32 v33, v20, v20, v9
    v_perm_b32 v34, v20, v20, v10
    v_perm_b32 v35, v20, v20, v11
    v_perm_b32 v36, v20, v20, v12
    v_perm_b32 v37, v20, v20, v13
    v_perm_b32 v38, v20, v20, v14
    v_perm_b32 v39, v20, v20, v15
    v_perm_b32 v40, v21, v21, v8
    v_perm_b32 v41, v21, v21, v9
    v_perm_b32 v42, v21, v21, v10
    v_perm_b32 v43, v21, v21, v11
    v_perm_b32 v44, v21, v21, v12
    v_perm_b32 v45, v21, v21, v13
    v_perm_b32 v46, v21, v21, v14
    v_perm_b32 v47, v21, v21, v15
    s_waitcnt vmcnt(8)
    v_mfma_f32_16x16x32_bf16 v[24:27], v[64:67], v[32:35], v[24:27]
    v_mfma_f32_16x16x32_bf16 v[28:31], v[68:71], v[32:35], v[28:31]
    v_mfma_f32_16x16x32_bf16 v[24:27], v[72:75], v[36:39], v[24:27]
    v_mfma_f32_16x16x32_bf16 v[28:31], v[76:79], v[36:39], v[28:31]
    v_mfma_f32_16x16x32_bf16 v[24:27], v[80:83], v[40:43], v[24:27]
    v_mfma_f32_16x16x32_bf16 v[28:31], v[84:87], v[40:43], v[28:31]
    v_mfma_f32_16x16x32_bf16 v[24:27], v[88:91], v[44:47], v[24:27]
    v_mfma_f32_16x16x32_bf16 v[28:31], v[92:95], v[44:47], v[28:31]
    v_perm_b32 v48, v22, v22, v8
    v_perm_b32 v49, v22, v22, v9
    v_perm_b32 v50, v22, v22, v10
    v_perm_b32 v51, v22, v22, v11
    v_perm_b32 v52, v22, v22, v12
    v_perm_b32 v53, v22, v22, v13
    v_perm_b32 v54, v22, v22, v14
    v_perm_b32 v55, v22, v22, v15
    v_perm_b32 v56, v23, v23, v8
    v_perm_b32 v57, v23, v23, v9
    v_perm_b32 v58, v23, v23, v10
    v_perm_b32 v59, v23, v23, v11
    v_perm_b32 v60, v23, v23, v12
    v_perm_b32 v61, v23, v23, v13
    v_perm_b32 v62, v23, v23, v14
    v_perm_b32 v63, v23, v23, v15
    s_waitcnt vmcnt(7)
    v_mfma_f32_16x16x32_bf16 v[24:27], v[96:99], v[48:51], v[24:27]
    s_waitcnt vmcnt(6)
    v_mfma_f32_16x16x32_bf16 v[28:31], v[100:103], v[48:51], v[28:31]
    s_waitcnt vmcnt(5)
    v_mfma_f32_16x16x32_bf16 v[24:27], v[104:107], v[52:55], v[24:27]
    s_waitcnt vmcnt(4)
    v_mfma_f32_16x16x32_bf16 v[28:31], v[108:111], v[52:55], v[28:31]
    s_waitcnt vmcnt(3)
    v_mfma_f32_16x16x32_bf16 v[24:27], v[112:115], v[56:59], v[24:27]
    s_waitcnt vmcnt(2)
    v_mfma_f32_16x16x32_bf16 v[28:31], v[116:119], v[56:59], v[28:31]
    s_waitcnt vmcnt(1)
    v_mfma_f32_16x16x32_bf16 v[24:27], v[120:123], v[60:63], v[24:27]
    s_waitcnt vmcnt(0)
    v_mfma_f32_16x16x32_bf16 v[28:31], v[124:127], v[60:63], v[28:31]
    s_nop 5
    ds_write_b128 v192, v[24:27] offset:16384
    s_nop 0
    ds_write_b128 v192, v[28:31] offset:17408
    s_mov_b64 exec, 1
    ds_add_u32 v200, v201 offset:16
    s_mov_b64 exec, -1
    s_cmp_lt_u32 s48, 4
    s_cbranch_scc1 L_oldtail
    s_mov_b32 s55, 0
L_s0w:
    ds_read_b32 v202, v200 offset:16
    ds_read_b64 v[36:37], v193 offset:16384
    ds_read_b64 v[38:39], v193 offset:18432
    ds_read_b64 v[40:41], v193 offset:20480
    ds_read_b64 v[42:43], v193 offset:22528
    ds_read_b64 v[44:45], v193 offset:24576
    ds_read_b64 v[46:47], v193 offset:26624
    ds_read_b64 v[48:49], v193 offset:28672
    ds_read_b64 v[50:51], v193 offset:30720
    s_add_u32 s55, s55, 1
    s_cmp_gt_u32 s55, 24000000
    s_cbranch_scc1 L_exit
    s_waitcnt lgkmcnt(8)
    v_readfirstlane_b32 s72, v202
    s_nop 0
    s_cmp_lt_u32 s72, 8
    s_cbranch_scc1 L_s0w
    s_waitcnt lgkmcnt(4)
    v_pk_add_f32 v[36:37], v[36:37], v[38:39]
    v_pk_add_f32 v[40:41], v[40:41], v[42:43]
    s_waitcnt lgkmcnt(0)
    v_pk_add_f32 v[44:45], v[44:45], v[46:47]
    v_pk_add_f32 v[48:49], v[48:49], v[50:51]
    v_pk_add_f32 v[36:37], v[36:37], v[40:41]
    v_pk_add_f32 v[44:45], v[44:45], v[48:49]
    v_add_f32 v196, v36, v44
    v_add_f32 v198, v37, v45
    global_store_dwordx4 v194, v[196:199], s[8:9] sc1
    s_mov_b64 exec, 1
    ds_add_u32 v200, v201 offset:16
    s_branch L_exit
L_oldtail:
    v_mov_b32 v63, 0
    s_mov_b32 s29, 0
    s_sub_u32 s68, s28, 192
    s_and_b32 s69, s68, 3
    s_lshl_b32 s69, s69, 1
    s_lshr_b32 s70, s68, 5
    s_add_u32 s69, s69, s70
    s_xor_b32 s69, s69, 2
    s_and_b32 s69, s69, 7
    s_lshl_b32 s69, s69, 3
    s_bfe_u32 s70, s68, 0x30002
    s_add_u32 s69, s69, s70
    s_cmp_lt_u32 s68, 64
    s_cselect_b32 s29, 1, s29
    s_cselect_b32 s49, s69, s49
    s_sub_u32 s68, s28, 64
    s_cmp_lt_u32 s68, 56
    s_cselect_b32 s29, 3, s29
    s_cselect_b32 s49, s68, s49
    s_sub_u32 s68, s28, 128
    s_and_b32 s70, s68, 0x38
    s_and_b32 s69, s68, 3
    s_lshl_b32 s69, s69, 1
    s_add_u32 s70, s70, s69
    s_bfe_u32 s69, s68, 0x10002
    s_add_u32 s70, s70, s69
    s_cmp_lt_u32 s68, 56
    s_cselect_b32 s29, 2, s29
    s_cselect_b32 s49, s70, s49
    s_cmp_eq_u32 s29, 2
    s_cbranch_scc1 L_ffn
    s_cmp_eq_u32 s29, 3
    s_cbranch_scc1 L_red
    s_cmp_eq_u32 s29, 0
    s_cbranch_scc1 L_exit
    s_and_b32 s68, s49, 7
    s_lshl_b32 s68, s68, 2
    s_add_u32 s68, s68, s48
    s_lshr_b32 s71, s49, 3
    s_sub_u32 s69, s71, 0
    s_and_b32 s70, s69, 3
    s_lshl_b32 s70, s70, 4
    s_lshr_b32 s72, s68, 1
    s_add_u32 s70, s70, s72
    s_lshl_b32 s70, s70, 14
    s_lshl_b32 s69, s69, 11
    s_xor_b32 s69, s69, s58
    s_and_b32 s69, s69, 0x2000
    s_add_u32 s70, s70, s69
    s_and_b32 s68, s68, 1
    s_lshl_b32 s68, s68, 12
    s_add_u32 s68, s68, s70
    s_add_u32 s68, s68, 2097152
    v_lshlrev_b32 v16, 11, v4
    v_lshl_add_u32 v16, v2, 7, v16
    v_lshl_add_u32 v16, v3, 4, v16
    v_add_u32 v16, s68, v16
    v_lshlrev_b32 v18, 7, v4
    v_lshl_add_u32 v19, v2, 5, v18
    v_and_b32 v23, 3, v3
    v_lshl_add_u32 v18, v23, 5, v18
    v_lshrrev_b32 v23, 2, v3
    v_lshl_add_u32 v18, v23, 2, v18
    s_lshl_b32 s68, s48, 3
    v_add_u32 v18, s68, v18
    s_lshl_b32 s68, s49, 7
    s_lshl_b32 s69, s48, 17
    s_add_u32 s68, s68, s69
    s_add_u32 s68, s68, 3145728
    s_add_u32 s68, s68, s58
    v_lshlrev_b32 v20, 15, v2
    v_lshl_add_u32 v20, v4, 14, v20
    v_lshl_add_u32 v20, v3, 4, v20
    v_add_u32 v20, s68, v20
    v_xor_b32 v21, 0x2000, v20
    v_mov_b32 v65, s53
    v_mov_b32 v67, s53
    v_mov_b32 v69, s53
    v_mov_b32 v71, s53
    s_lshl_b32 s68, s71, 11
    s_and_b32 s69, s48, 1
    s_lshl_b32 s69, s69, 4
    s_add_u32 s68, s68, s69
    s_add_u32 s68, s68, 65536
    v_lshlrev_b32 v23, 14, v4
    v_lshl_add_u32 v23, v2, 7, v23
    v_add_u32 v23, s68, v23
    s_mov_b32 s55, 0
Lspin_133:
    ds_read_b32 v24, v63 offset:20
    s_add_u32 s55, s55, 1
    s_cmp_gt_u32 s55, 48000000
    s_cbranch_scc1 L_exit
    s_waitcnt lgkmcnt(0)
    v_readfirstlane_b32 s72, v24
    s_nop 0
    s_cmp_ge_u32 s72, 4
    s_cbranch_scc1 Lsok_134
    s_sleep 1
    s_branch Lspin_133
Lsok_134:
    global_load_dwordx4 v[72:75], v23, s[30:31] offset:0 sc1
    global_load_dwordx4 v[76:79], v23, s[30:31] offset:512 sc1
    global_load_dwordx4 v[80:83], v23, s[30:31] offset:1024 sc1
    global_load_dwordx4 v[84:87], v23, s[30:31] offset:1536 sc1
    v_mul_u32_u24 v36, 896, v2
    v_lshl_add_u32 v36, v1, 4, v36
    v_lshlrev_b32 v37, 30, v4
    v_add_u32 v37, v37, v36
    s_cmp_eq_u32 s48, 3
    s_cselect_b64 vcc, -1, 0
    v_cndmask_b32 v36, v36, v37, vcc
    s_and_b32 s68, s49, 7
    s_lshl_b32 s68, s68, 5
    s_lshr_b32 s71, s49, 3
    s_lshl_b32 s71, s71, 9
    s_add_u32 s68, s68, s71
    s_mul_i32 s68, s68, 896
    s_lshl_b32 s71, s48, 8
    s_add_u32 s68, s68, s71
    s_waitcnt vmcnt(9)
    s_add_u32 s69, s68, 0
    buffer_load_dwordx4 v[128:131], v36, s[40:43], s69 offen nt
    s_waitcnt vmcnt(9)
    s_add_u32 s69, s68, 7168
    buffer_load_dwordx4 v[132:135], v36, s[40:43], s69 offen nt
    s_waitcnt vmcnt(9)
    s_add_u32 s69, s68, 3584
    buffer_load_dwordx4 v[136:139], v36, s[40:43], s69 offen nt
    s_waitcnt vmcnt(9)
    s_add_u32 s69, s68, 10752
    buffer_load_dwordx4 v[140:143], v36, s[40:43], s69 offen nt
    s_waitcnt vmcnt(9)
    s_add_u32 s69, s68, 229376
    buffer_load_dwordx4 v[144:147], v36, s[40:43], s69 offen nt
    s_waitcnt vmcnt(9)
    s_add_u32 s69, s68, 236544
    buffer_load_dwordx4 v[148:151], v36, s[40:43], s69 offen nt
    s_waitcnt vmcnt(9)
    s_add_u32 s69, s68, 232960
    buffer_load_dwordx4 v[152:155], v36, s[40:43], s69 offen nt
    s_waitcnt vmcnt(9)
    s_add_u32 s69, s68, 240128
    buffer_load_dwordx4 v[156:159], v36, s[40:43], s69 offen nt
    s_waitcnt vmcnt(9)
    s_add_u32 s69, s68, 14336
    buffer_load_dwordx4 v[160:163], v36, s[40:43], s69 offen nt
    s_waitcnt vmcnt(9)
    s_add_u32 s69, s68, 21504
    buffer_load_dwordx4 v[164:167], v36, s[40:43], s69 offen nt
    s_waitcnt vmcnt(9)
    s_add_u32 s69, s68, 17920
    buffer_load_dwordx4 v[168:171], v36, s[40:43], s69 offen nt
    s_waitcnt vmcnt(9)
    s_add_u32 s69, s68, 25088
    buffer_load_dwordx4 v[172:175], v36, s[40:43], s69 offen nt
    s_waitcnt vmcnt(9)
    s_add_u32 s69, s68, 243712
    buffer_load_dwordx4 v[176:179], v36, s[40:43], s69 offen nt
    s_waitcnt vmcnt(9)
    s_add_u32 s69, s68, 250880
    buffer_load_dwordx4 v[180:183], v36, s[40:43], s69 offen nt
    s_waitcnt vmcnt(9)
    s_add_u32 s69, s68, 247296
    buffer_load_dwordx4 v[184:187], v36, s[40:43], s69 offen nt
    s_waitcnt vmcnt(9)
    s_add_u32 s69, s68, 254464
    buffer_load_dwordx4 v[188:191], v36, s[40:43], s69 offen nt
    s_mov_b32 s55, 0
    s_waitcnt vmcnt(16)
    s_branch L_wsc
    s_mov_b32 s55, 0
    s_nop 1
Lpoll_135:
    global_load_dwordx4 v[72:75], v23, s[30:31] offset:0 sc1
    global_load_dwordx4 v[76:79], v23, s[30:31] offset:512 sc1
    global_load_dwordx4 v[80:83], v23, s[30:31] offset:1024 sc1
    global_load_dwordx4 v[84:87], v23, s[30:31] offset:1536 sc1
    s_waitcnt vmcnt(0)
L_wsc:
    v_cmp_ne_u32 s[74:75], s53, v73
    v_cmp_ne_u32 s[78:79], s53, v75
    s_nop 0
    s_or_b64 s[74:75], s[74:75], s[78:79]
    v_cmp_ne_u32 s[80:81], s53, v77
    s_nop 0
    s_or_b64 s[74:75], s[74:75], s[80:81]
    v_cmp_ne_u32 s[76:77], s53, v79
    s_nop 0
    s_or_b64 s[74:75], s[74:75], s[76:77]
    v_cmp_ne_u32 s[78:79], s53, v81
    s_nop 0
    s_or_b64 s[74:75], s[74:75], s[78:79]
    v_cmp_ne_u32 s[80:81], s53, v83
    s_nop 0
    s_or_b64 s[74:75], s[74:75], s[80:81]
    v_cmp_ne_u32 s[76:77], s53, v85
    s_nop 0
    s_or_b64 s[74:75], s[74:75], s[76:77]
    v_cmp_ne_u32 s[78:79], s53, v87
    s_nop 0
    s_or_b64 s[74:75], s[74:75], s[78:79]
    s_cmp_eq_u64 s[74:75], 0
    s_cbranch_scc1 Lok_136
    s_add_u32 s55, s55, 1
    s_cmp_gt_u32 s55, 3000000
    s_cbranch_scc1 L_exit
    s_branch Lpoll_135
Lok_136:
    v_max3_f32 v88, v72, v76, v80
    v_max_f32 v88, v88, v84
    v_mov_b32 v89, v88
    s_nop 1
    v_permlane16_swap_b32 v88, v89
    v_max_f32 v88, v88, v89
    v_mov_b32 v89, v88
    s_nop 1
    v_permlane32_swap_b32 v88, v89
    v_max_f32 v88, v88, v89
    v_sub_f32 v72, v72, v88
    v_sub_f32 v76, v76, v88
    v_sub_f32 v80, v80, v88
    v_sub_f32 v84, v84, v88
    v_mul_f32 v72, s3, v72
    v_mul_f32 v76, s3, v76
    v_mul_f32 v80, s3, v80
    v_mul_f32 v84, s3, v84
    v_exp_f32 v72, v72
    v_exp_f32 v76, v76
    v_exp_f32 v80, v80
    v_exp_f32 v84, v84
    v_mul_f32 v88, v72, v74
    v_fmac_f32 v88, v76, v78
    v_fmac_f32 v88, v80, v82
    v_fmac_f32 v88, v84, v86
    v_mov_b32 v89, v88
    s_nop 1
    v_permlane16_swap_b32 v88, v89
    v_add_f32 v88, v88, v89
    v_mov_b32 v89, v88
    s_nop 1
    v_permlane32_swap_b32 v88, v89
    v_add_f32 v88, v88, v89
    v_rcp_f32 v88, v88
    s_nop 0
    v_mul_f32 v72, v72, v88
    v_mul_f32 v76, v76, v88
    v_mul_f32 v80, v80, v88
    v_mul_f32 v84, v84, v88
    s_mov_b32 s55, 0
Lpc_137:
    global_load_dwordx4 v[192:195], v16, s[8:9] offset:0 sc1
    global_load_dwordx4 v[196:199], v16, s[8:9] offset:512 sc1
    global_load_dwordx4 v[200:203], v16, s[8:9] offset:1024 sc1
    global_load_dwordx4 v[204:207], v16, s[8:9] offset:1536 sc1
    s_waitcnt vmcnt(3)
    v_cmpx_eq_u32 s[74:75], s53, v193
    v_cmpx_eq_u32 s[74:75], s53, v195
    s_waitcnt vmcnt(2)
    v_cmpx_eq_u32 s[74:75], s53, v197
    v_cmpx_eq_u32 s[74:75], s53, v199
    s_waitcnt vmcnt(1)
    v_cmpx_eq_u32 s[74:75], s53, v201
    v_cmpx_eq_u32 s[74:75], s53, v203
    s_waitcnt vmcnt(0)
    v_cmpx_eq_u32 s[74:75], s53, v205
    v_cmpx_eq_u32 s[74:75], s53, v207
    s_mov_b64 exec, -1
    s_cmp_eq_u64 s[74:75], -1
    s_cbranch_scc1 Lpk_139
    s_add_u32 s55, s55, 1
    s_cmp_gt_u32 s55, 3000000
    s_cbranch_scc0 Lpc_137
    s_branch L_exit
Lpk_139:
    v_mul_f32 v24, v192, v72
    v_mul_f32 v26, v194, v72
    v_mul_f32 v32, v200, v80
    v_mul_f32 v34, v202, v80
    v_fmac_f32 v24, v196, v76
    v_fmac_f32 v26, v198, v76
    v_fmac_f32 v32, v204, v84
    v_fmac_f32 v34, v206, v84
Lpd_138:
    v_add_f32 v24, v24, v32
    v_add_f32 v26, v26, v34
    v_mov_b32 v28, v24
    v_mov_b32 v29, v26
    s_nop 0
    v_permlane16_swap_b32 v24, v28
    v_permlane16_swap_b32 v26, v29
    v_add_f32 v24, v24, v28
    v_add_f32 v26, v26, v29
    v_mov_b32 v28, v24
    v_mov_b32 v29, v26
    s_nop 0
    v_permlane32_swap_b32 v24, v28
    v_permlane32_swap_b32 v26, v29
    v_add_f32 v24, v24, v28
    v_add_f32 v26, v26, v29
    v_cvt_pk_bf16_f32 v26, v24, v26
    ds_write_b32 v18, v26 offset:32768
    s_waitcnt lgkmcnt(0)
    s_barrier
    ds_read_b128 v[24:27], v19 offset:32768
    ds_read_b128 v[28:31], v19 offset:32784
    s_waitcnt lgkmcnt(1)
    v_perm_b32 v32, v24, v24, v8
    v_perm_b32 v33, v24, v24, v9
    v_perm_b32 v34, v24, v24, v10
    v_perm_b32 v35, v24, v24, v11
    v_perm_b32 v36, v24, v24, v12
    v_perm_b32 v37, v24, v24, v13
    v_perm_b32 v38, v24, v24, v14
    v_perm_b32 v39, v24, v24, v15
    v_mfma_f32_16x16x32_bf16 v[48:51], v[128:131], v[32:35], 0
    v_perm_b32 v40, v25, v25, v8
    v_perm_b32 v41, v25, v25, v9
    v_perm_b32 v42, v25, v25, v10
    v_perm_b32 v43, v25, v25, v11
    v_mfma_f32_16x16x32_bf16 v[48:51], v[132:135], v[36:39], v[48:51]
    v_perm_b32 v44, v25, v25, v12
    v_perm_b32 v45, v25, v25, v13
    v_perm_b32 v46, v25, v25, v14
    v_perm_b32 v47, v25, v25, v15
    v_mfma_f32_16x16x32_bf16 v[48:51], v[136:139], v[40:43], v[48:51]
    v_perm_b32 v32, v26, v26, v8
    v_perm_b32 v33, v26, v26, v9
    v_perm_b32 v34, v26, v26, v10
    v_perm_b32 v35, v26, v26, v11
    v_mfma_f32_16x16x32_bf16 v[48:51], v[140:143], v[44:47], v[48:51]
    v_perm_b32 v36, v26, v26, v12
    v_perm_b32 v37, v26, v26, v13
    v_perm_b32 v38, v26, v26, v14
    v_perm_b32 v39, v26, v26, v15
    v_mfma_f32_16x16x32_bf16 v[48:51], v[144:147], v[32:35], v[48:51]
    v_perm_b32 v40, v27, v27, v8
    v_perm_b32 v41, v27, v27, v9
    v_perm_b32 v42, v27, v27, v10
    v_perm_b32 v43, v27, v27, v11
    v_mfma_f32_16x16x32_bf16 v[48:51], v[148:151], v[36:39], v[48:51]
    v_perm_b32 v44, v27, v27, v12
    v_perm_b32 v45, v27, v27, v13
    v_perm_b32 v46, v27, v27, v14
    v_perm_b32 v47, v27, v27, v15
    v_mfma_f32_16x16x32_bf16 v[48:51], v[152:155], v[40:43], v[48:51]
    s_waitcnt lgkmcnt(0)
    v_perm_b32 v32, v28, v28, v8
    v_perm_b32 v33, v28, v28, v9
    v_perm_b32 v34, v28, v28, v10
    v_perm_b32 v35, v28, v28, v11
    v_mfma_f32_16x16x32_bf16 v[48:51], v[156:159], v[44:47], v[48:51]
    v_perm_b32 v36, v28, v28, v12
    v_perm_b32 v37, v28, v28, v13
    v_perm_b32 v38, v28, v28, v14
    v_perm_b32 v39, v28, v28, v15
    v_mfma_f32_16x16x32_bf16 v[48:51], v[160:163], v[32:35], v[48:51]
    v_perm_b32 v40, v29, v29, v8
    v_perm_b32 v41, v29, v29, v9
    v_perm_b32 v42, v29, v29, v10
    v_perm_b32 v43, v29, v29, v11
    v_mfma_f32_16x16x32_bf16 v[48:51], v[164:167], v[36:39], v[48:51]
    v_perm_b32 v44, v29, v29, v12
    v_perm_b32 v45, v29, v29, v13
    v_perm_b32 v46, v29, v29, v14
    v_perm_b32 v47, v29, v29, v15
    v_mfma_f32_16x16x32_bf16 v[48:51], v[168:171], v[40:43], v[48:51]
    v_perm_b32 v32, v30, v30, v8
    v_perm_b32 v33, v30, v30, v9
    v_perm_b32 v34, v30, v30, v10
    v_perm_b32 v35, v30, v30, v11
    v_mfma_f32_16x16x32_bf16 v[48:51], v[172:175], v[44:47], v[48:51]
    v_perm_b32 v36, v30, v30, v12
    v_perm_b32 v37, v30, v30, v13
    v_perm_b32 v38, v30, v30, v14
    v_perm_b32 v39, v30, v30, v15
    v_mfma_f32_16x16x32_bf16 v[48:51], v[176:179], v[32:35], v[48:51]
    v_perm_b32 v40, v31, v31, v8
    v_perm_b32 v41, v31, v31, v9
    v_perm_b32 v42, v31, v31, v10
    v_perm_b32 v43, v31, v31, v11
    v_mfma_f32_16x16x32_bf16 v[48:51], v[180:183], v[36:39], v[48:51]
    v_perm_b32 v44, v31, v31, v12
    v_perm_b32 v45, v31, v31, v13
    v_perm_b32 v46, v31, v31, v14
    v_perm_b32 v47, v31, v31, v15
    v_mfma_f32_16x16x32_bf16 v[48:51], v[184:187], v[40:43], v[48:51]
    s_nop 0
    v_mfma_f32_16x16x32_bf16 v[48:51], v[188:191], v[44:47], v[48:51]
    s_cmp_eq_u32 s48, 3
    s_cselect_b32 exec_hi, 0, -1
    s_nop 5
    v_mov_b32 v64, v48
    v_mov_b32 v66, v49
    v_mov_b32 v68, v50
    v_mov_b32 v70, v51
    global_store_dwordx4 v20, v[64:67], s[8:9] sc1
    global_store_dwordx4 v21, v[68:71], s[8:9] sc1
    s_mov_b64 exec, -1
    s_branch L_exit
L_red:
    s_cmp_lg_u32 s48, 2
    s_cbranch_scc1 L_exit
    s_lshr_b32 s68, s49, 1
    s_lshl_b32 s68, s68, 4
    s_and_b32 s69, s49, 1
    v_add_u32 v17, s68, v3
    s_mul_i32 s70, s69, 896
    v_lshlrev_b32 v18, 1, v17
    v_add_u32 v18, s70, v18
    global_load_ushort v40, v18, s[4:5]
    global_load_ushort v41, v18, s[4:5] offset:16
    s_lshl_b32 s71, s69, 3
    v_lshrrev_b32 v19, 1, v17
    v_lshlrev_b32 v19, 4, v19
    v_add_u32 v19, s71, v19
    v_add_u32 v20, 12288, v19
    v_add_u32 v21, 24576, v19
    s_mov_b32 s55, 0
    s_nop 3
Lpoll_140:
    global_load_dwordx2 v[42:43], v20, s[30:31] sc1
    global_load_dwordx2 v[44:45], v20, s[30:31] offset:64 sc1
    global_load_dwordx2 v[46:47], v21, s[30:31] sc1
    global_load_dwordx2 v[48:49], v21, s[30:31] offset:64 sc1
    s_waitcnt vmcnt(0)
    v_cmp_ne_u32 s[74:75], s53, v43
    v_cmp_ne_u32 s[78:79], s53, v45
    s_nop 0
    s_or_b64 s[74:75], s[74:75], s[78:79]
    v_cmp_ne_u32 s[80:81], s53, v47
    s_nop 0
    s_or_b64 s[74:75], s[74:75], s[80:81]
    v_cmp_ne_u32 s[76:77], s53, v49
    s_nop 0
    s_or_b64 s[74:75], s[74:75], s[76:77]
    s_cmp_eq_u64 s[74:75], 0
    s_cbranch_scc1 Lok_141
    s_add_u32 s55, s55, 1
    s_cmp_gt_u32 s55, 3000000
    s_cbranch_scc1 L_exit
    s_branch Lpoll_140
Lok_141:
    v_and_b32 v22, 1, v3
    v_xor_b32 v23, 1, v22
    v_lshlrev_b32 v23, 4, v23
    v_lshlrev_b32 v42, v23, v42
    v_and_b32 v42, s14, v42
    v_lshlrev_b32 v44, v23, v44
    v_and_b32 v44, s14, v44
    v_lshlrev_b32 v46, v23, v46
    v_and_b32 v46, s14, v46
    v_lshlrev_b32 v48, v23, v48
    v_and_b32 v48, s14, v48
    v_lshlrev_b32 v40, 16, v40
    v_lshlrev_b32 v41, 16, v41
    v_lshrrev_b32 v23, 1, v3
    v_lshl_add_u32 v23, v22, 2, v23
    s_lshl_b32 s71, s49, 7
    v_lshlrev_b32 v24, 3, v23
    v_add_u32 v24, s71, v24
    v_lshl_add_u32 v24, v4, 13, v24
    v_add_u32 v24, 4063232, v24
    s_lshl_b32 s68, s68, 1
    s_add_u32 s70, s70, s68
    v_lshlrev_b32 v25, 2, v23
    v_add_u32 v25, s70, v25
    s_lshr_b32 s68, s49, 2
    s_lshl_b32 s68, s68, 1
    s_add_u32 s68, s68, s69
    s_lshl_b32 s68, s68, 14
    s_lshl_b32 s71, s49, 12
    s_xor_b32 s71, s71, s58
    s_and_b32 s71, s71, 0x2000
    s_add_u32 s68, s68, s71
    s_add_u32 s68, s68, 3149824
    v_lshlrev_b32 v28, 4, v0
    v_add_u32 v28, s68, v28
    s_add_u32 s64, s8, 458752
    s_addc_u32 s65, s9, 0
    v_mov_b32 v51, s53
    v_mov_b32 v52, 0
    s_mov_b32 s55, 0
Lspin_142:
    ds_read_b32 v53, v52 offset:16
    s_add_u32 s55, s55, 1
    s_cmp_gt_u32 s55, 48000000
    s_cbranch_scc1 L_exit
    s_waitcnt lgkmcnt(0)
    v_readfirstlane_b32 s72, v53
    s_nop 0
    s_cmp_ge_u32 s72, 12
    s_cbranch_scc1 Lsok_143
    s_sleep 1
    s_branch Lspin_142
Lsok_143:
    s_mov_b64 vcc, 0xaaaa
    s_mov_b32 s55, 0
    global_load_dwordx4 v[128:131], v28, s[8:9] offset:-4096 sc1
    global_load_dwordx4 v[132:135], v28, s[8:9] offset:-3072 sc1
    global_load_dwordx4 v[136:139], v28, s[8:9] offset:-2048 sc1
    global_load_dwordx4 v[140:143], v28, s[8:9] offset:-1024 sc1
    global_load_dwordx4 v[144:147], v28, s[8:9] offset:0 sc1
    global_load_dwordx4 v[148:151], v28, s[8:9] offset:1024 sc1
    global_load_dwordx4 v[152:155], v28, s[8:9] offset:2048 sc1
    global_load_dwordx4 v[156:159], v28, s[8:9] offset:3072 sc1
Lpc_144:
    global_load_dwordx4 v[160:163], v28, s[8:9] offset:-4096 sc1
    global_load_dwordx4 v[164:167], v28, s[8:9] offset:-3072 sc1
    global_load_dwordx4 v[168:171], v28, s[8:9] offset:-2048 sc1
    global_load_dwordx4 v[172:175], v28, s[8:9] offset:-1024 sc1
    global_load_dwordx4 v[176:179], v28, s[8:9] offset:0 sc1
    global_load_dwordx4 v[180:183], v28, s[8:9] offset:1024 sc1
    global_load_dwordx4 v[184:187], v28, s[8:9] offset:2048 sc1
    global_load_dwordx4 v[188:191], v28, s[8:9] offset:3072 sc1
    s_waitcnt vmcnt(15)
    v_cmpx_eq_u32 s[74:75], s53, v129
    v_cmpx_eq_u32 s[74:75], s53, v131
    s_waitcnt vmcnt(14)
    v_cmpx_eq_u32 s[74:75], s53, v133
    v_cmpx_eq_u32 s[74:75], s53, v135
    s_waitcnt vmcnt(13)
    v_cmpx_eq_u32 s[74:75], s53, v137
    v_cmpx_eq_u32 s[74:75], s53, v139
    s_waitcnt vmcnt(12)
    v_cmpx_eq_u32 s[74:75], s53, v141
    v_cmpx_eq_u32 s[74:75], s53, v143
    s_waitcnt vmcnt(11)
    v_cmpx_eq_u32 s[74:75], s53, v145
    v_cmpx_eq_u32 s[74:75], s53, v147
    s_waitcnt vmcnt(10)
    v_cmpx_eq_u32 s[74:75], s53, v149
    v_cmpx_eq_u32 s[74:75], s53, v151
    s_waitcnt vmcnt(9)
    v_cmpx_eq_u32 s[74:75], s53, v153
    v_cmpx_eq_u32 s[74:75], s53, v155
    s_waitcnt vmcnt(8)
    v_cmpx_eq_u32 s[74:75], s53, v157
    v_cmpx_eq_u32 s[74:75], s53, v159
    s_mov_b64 exec, -1
    s_cmp_eq_u64 s[74:75], -1
    s_cbranch_scc1 Lpk_146
    global_load_dwordx4 v[128:131], v28, s[8:9] offset:-4096 sc1
    global_load_dwordx4 v[132:135], v28, s[8:9] offset:-3072 sc1
    global_load_dwordx4 v[136:139], v28, s[8:9] offset:-2048 sc1
    global_load_dwordx4 v[140:143], v28, s[8:9] offset:-1024 sc1
    global_load_dwordx4 v[144:147], v28, s[8:9] offset:0 sc1
    global_load_dwordx4 v[148:151], v28, s[8:9] offset:1024 sc1
    global_load_dwordx4 v[152:155], v28, s[8:9] offset:2048 sc1
    global_load_dwordx4 v[156:159], v28, s[8:9] offset:3072 sc1
    s_waitcnt vmcnt(15)
    v_cmpx_eq_u32 s[74:75], s53, v161
    v_cmpx_eq_u32 s[74:75], s53, v163
    s_waitcnt vmcnt(14)
    v_cmpx_eq_u32 s[74:75], s53, v165
    v_cmpx_eq_u32 s[74:75], s53, v167
    s_waitcnt vmcnt(13)
    v_cmpx_eq_u32 s[74:75], s53, v169
    v_cmpx_eq_u32 s[74:75], s53, v171
    s_waitcnt vmcnt(12)
    v_cmpx_eq_u32 s[74:75], s53, v173
    v_cmpx_eq_u32 s[74:75], s53, v175
    s_waitcnt vmcnt(11)
    v_cmpx_eq_u32 s[74:75], s53, v177
    v_cmpx_eq_u32 s[74:75], s53, v179
    s_waitcnt vmcnt(10)
    v_cmpx_eq_u32 s[74:75], s53, v181
    v_cmpx_eq_u32 s[74:75], s53, v183
    s_waitcnt vmcnt(9)
    v_cmpx_eq_u32 s[74:75], s53, v185
    v_cmpx_eq_u32 s[74:75], s53, v187
    s_waitcnt vmcnt(8)
    v_cmpx_eq_u32 s[74:75], s53, v189
    v_cmpx_eq_u32 s[74:75], s53, v191
    s_mov_b64 exec, -1
    s_cmp_eq_u64 s[74:75], -1
    s_cbranch_scc1 Lpk_147
    s_add_u32 s55, s55, 1
    s_cmp_gt_u32 s55, 3000000
    s_cbranch_scc0 Lpc_144
    s_branch L_exit
Lpk_146:
    v_add_f32 v64, v128, v132
    v_add_f32 v66, v130, v134
    v_add_f32 v68, v136, v140
    v_add_f32 v70, v138, v142
    v_add_f32 v72, v144, v148
    v_add_f32 v74, v146, v150
    v_add_f32 v76, v152, v156
    v_add_f32 v78, v154, v158
    s_branch Lpd_145
Lpk_147:
    v_add_f32 v64, v160, v164
    v_add_f32 v66, v162, v166
    v_add_f32 v68, v168, v172
    v_add_f32 v70, v170, v174
    v_add_f32 v72, v176, v180
    v_add_f32 v74, v178, v182
    v_add_f32 v76, v184, v188
    v_add_f32 v78, v186, v190
Lpd_145:
    v_add_f32 v64, v64, v68
    v_add_f32 v66, v66, v70
    v_add_f32 v72, v72, v76
    v_add_f32 v74, v74, v78
    v_add_f32 v64, v64, v72
    v_add_f32 v66, v66, v74
    s_nop 0
    v_add_f32_dpp v64, v64, v64 row_ror:8 row_mask:0xf bank_mask:0xf
    v_add_f32_dpp v66, v66, v66 row_ror:8 row_mask:0xf bank_mask:0xf
    v_mov_b32 v100, v64
    v_mov_b32 v101, v66
    s_nop 0
    v_permlane16_swap_b32 v64, v100
    v_permlane16_swap_b32 v66, v101
    v_add_f32 v64, v64, v100
    v_add_f32 v66, v66, v101
    v_mov_b32 v100, v64
    v_mov_b32 v101, v66
    s_nop 0
    v_permlane32_swap_b32 v64, v100
    v_permlane32_swap_b32 v66, v101
    v_add_f32 v64, v64, v100
    v_add_f32 v66, v66, v101
    v_cvt_pk_bf16_f32 v66, v64, v66
    v_lshlrev_b32 v64, 16, v66
    v_and_b32 v66, s14, v66
    v_mul_f32 v64, v64, v42
    v_mul_f32 v66, v66, v44
    v_cvt_pk_bf16_f32 v66, v64, v66
    v_lshlrev_b32 v64, 16, v66
    v_and_b32 v66, s14, v66
    v_add_f32 v40, v40, v64
    v_add_f32 v41, v41, v66
    s_nop 0
    v_mov_b32_dpp v102, v40 quad_perm:[0,0,2,2] row_mask:0xf bank_mask:0xf
    v_mov_b32_dpp v103, v40 quad_perm:[1,1,3,3] row_mask:0xf bank_mask:0xf
    v_mov_b32_dpp v104, v41 quad_perm:[0,0,2,2] row_mask:0xf bank_mask:0xf
    v_mov_b32_dpp v105, v41 quad_perm:[1,1,3,3] row_mask:0xf bank_mask:0xf
    v_cvt_pk_bf16_f32 v102, v102, v103
    v_cvt_pk_bf16_f32 v104, v104, v105
    v_cndmask_b32 v50, v102, v104, vcc
    s_mov_b64 exec, 0xffff
    global_store_dwordx2 v24, v[50:51], s[8:9] sc1
    s_mov_b64 exec, -1
    v_cvt_pk_bf16_f32 v41, v40, v41
    v_lshlrev_b32 v40, 16, v41
    v_and_b32 v41, s14, v41
    s_mov_b32 s55, 0
    global_load_dwordx4 v[128:131], v28, s[64:65] offset:-4096 sc1
    global_load_dwordx4 v[132:135], v28, s[64:65] offset:-3072 sc1
    global_load_dwordx4 v[136:139], v28, s[64:65] offset:-2048 sc1
    global_load_dwordx4 v[140:143], v28, s[64:65] offset:-1024 sc1
    global_load_dwordx4 v[144:147], v28, s[64:65] offset:0 sc1
    global_load_dwordx4 v[148:151], v28, s[64:65] offset:1024 sc1
    global_load_dwordx4 v[152:155], v28, s[64:65] offset:2048 sc1
Lpc_148:
    global_load_dwordx4 v[160:163], v28, s[64:65] offset:-4096 sc1
    global_load_dwordx4 v[164:167], v28, s[64:65] offset:-3072 sc1
    global_load_dwordx4 v[168:171], v28, s[64:65] offset:-2048 sc1
    global_load_dwordx4 v[172:175], v28, s[64:65] offset:-1024 sc1
    global_load_dwordx4 v[176:179], v28, s[64:65] offset:0 sc1
    global_load_dwordx4 v[180:183], v28, s[64:65] offset:1024 sc1
    global_load_dwordx4 v[184:187], v28, s[64:65] offset:2048 sc1
    s_waitcnt vmcnt(13)
    v_cmpx_eq_u32 s[74:75], s53, v129
    v_cmpx_eq_u32 s[74:75], s53, v131
    s_waitcnt vmcnt(12)
    v_cmpx_eq_u32 s[74:75], s53, v133
    v_cmpx_eq_u32 s[74:75], s53, v135
    s_waitcnt vmcnt(11)
    v_cmpx_eq_u32 s[74:75], s53, v137
    v_cmpx_eq_u32 s[74:75], s53, v139
    s_waitcnt vmcnt(10)
    v_cmpx_eq_u32 s[74:75], s53, v141
    v_cmpx_eq_u32 s[74:75], s53, v143
    s_waitcnt vmcnt(9)
    v_cmpx_eq_u32 s[74:75], s53, v145
    v_cmpx_eq_u32 s[74:75], s53, v147
    s_waitcnt vmcnt(8)
    v_cmpx_eq_u32 s[74:75], s53, v149
    v_cmpx_eq_u32 s[74:75], s53, v151
    s_waitcnt vmcnt(7)
    v_cmpx_eq_u32 s[74:75], s53, v153
    v_cmpx_eq_u32 s[74:75], s53, v155
    s_mov_b64 exec, -1
    s_cmp_eq_u64 s[74:75], -1
    s_cbranch_scc1 Lpk_150
    global_load_dwordx4 v[128:131], v28, s[64:65] offset:-4096 sc1
    global_load_dwordx4 v[132:135], v28, s[64:65] offset:-3072 sc1
    global_load_dwordx4 v[136:139], v28, s[64:65] offset:-2048 sc1
    global_load_dwordx4 v[140:143], v28, s[64:65] offset:-1024 sc1
    global_load_dwordx4 v[144:147], v28, s[64:65] offset:0 sc1
    global_load_dwordx4 v[148:151], v28, s[64:65] offset:1024 sc1
    global_load_dwordx4 v[152:155], v28, s[64:65] offset:2048 sc1
    s_waitcnt vmcnt(13)
    v_cmpx_eq_u32 s[74:75], s53, v161
    v_cmpx_eq_u32 s[74:75], s53, v163
    s_waitcnt vmcnt(12)
    v_cmpx_eq_u32 s[74:75], s53, v165
    v_cmpx_eq_u32 s[74:75], s53, v167
    s_waitcnt vmcnt(11)
    v_cmpx_eq_u32 s[74:75], s53, v169
    v_cmpx_eq_u32 s[74:75], s53, v171
    s_waitcnt vmcnt(10)
    v_cmpx_eq_u32 s[74:75], s53, v173
    v_cmpx_eq_u32 s[74:75], s53, v175
    s_waitcnt vmcnt(9)
    v_cmpx_eq_u32 s[74:75], s53, v177
    v_cmpx_eq_u32 s[74:75], s53, v179
    s_waitcnt vmcnt(8)
    v_cmpx_eq_u32 s[74:75], s53, v181
    v_cmpx_eq_u32 s[74:75], s53, v183
    s_waitcnt vmcnt(7)
    v_cmpx_eq_u32 s[74:75], s53, v185
    v_cmpx_eq_u32 s[74:75], s53, v187
    s_mov_b64 exec, -1
    s_cmp_eq_u64 s[74:75], -1
    s_cbranch_scc1 Lpk_151
    s_add_u32 s55, s55, 1
    s_cmp_gt_u32 s55, 3000000
    s_cbranch_scc0 Lpc_148
    s_branch L_exit
Lpk_150:
    v_add_f32 v64, v128, v132
    v_add_f32 v66, v130, v134
    v_add_f32 v68, v136, v140
    v_add_f32 v70, v138, v142
    v_add_f32 v72, v144, v148
    v_add_f32 v74, v146, v150
    v_mov_b32 v76, v152
    v_mov_b32 v78, v154
    s_branch Lpd_149
Lpk_151:
    v_add_f32 v64, v160, v164
    v_add_f32 v66, v162, v166
    v_add_f32 v68, v168, v172
    v_add_f32 v70, v170, v174
    v_add_f32 v72, v176, v180
    v_add_f32 v74, v178, v182
    v_mov_b32 v76, v184
    v_mov_b32 v78, v186
Lpd_149:
    v_add_f32 v64, v64, v68
    v_add_f32 v66, v66, v70
    v_add_f32 v72, v72, v76
    v_add_f32 v74, v74, v78
    v_add_f32 v64, v64, v72
    v_add_f32 v66, v66, v74
    s_nop 0
    v_add_f32_dpp v64, v64, v64 row_ror:8 row_mask:0xf bank_mask:0xf
    v_add_f32_dpp v66, v66, v66 row_ror:8 row_mask:0xf bank_mask:0xf
    v_mov_b32 v100, v64
    v_mov_b32 v101, v66
    s_nop 0
    v_permlane16_swap_b32 v64, v100
    v_permlane16_swap_b32 v66, v101
    v_add_f32 v64, v64, v100
    v_add_f32 v66, v66, v101
    v_mov_b32 v100, v64
    v_mov_b32 v101, v66
    s_nop 0
    v_permlane32_swap_b32 v64, v100
    v_permlane32_swap_b32 v66, v101
    v_add_f32 v64, v64, v100
    v_add_f32 v66, v66, v101
    v_cvt_pk_bf16_f32 v66, v64, v66
    v_lshlrev_b32 v64, 16, v66
    v_and_b32 v66, s14, v66
    v_mul_f32 v64, v64, v46
    v_mul_f32 v66, v66, v48
    v_cvt_pk_bf16_f32 v66, v64, v66
    v_lshlrev_b32 v64, 16, v66
    v_and_b32 v66, s14, v66
    v_add_f32 v40, v40, v64
    v_add_f32 v41, v41, v66
    s_nop 0
    v_mov_b32_dpp v102, v40 quad_perm:[0,0,2,2] row_mask:0xf bank_mask:0xf
    v_mov_b32_dpp v103, v40 quad_perm:[1,1,3,3] row_mask:0xf bank_mask:0xf
    v_mov_b32_dpp v104, v41 quad_perm:[0,0,2,2] row_mask:0xf bank_mask:0xf
    v_mov_b32_dpp v105, v41 quad_perm:[1,1,3,3] row_mask:0xf bank_mask:0xf
    v_cvt_pk_bf16_f32 v102, v102, v103
    v_cvt_pk_bf16_f32 v104, v104, v105
    v_cndmask_b32 v50, v102, v104, vcc
    s_mov_b64 exec, 0xff
    global_store_dword v25, v50, s[26:27]
    s_cmp_lg_u32 s49, 0
    s_cbranch_scc1 L_noep
    s_mov_b64 exec, 1
    v_mov_b32 v52, 0
    global_store_dword v52, v51, s[30:31] sc1
L_noep:
    s_mov_b64 exec, -1
    s_branch L_exit
L_ffn:
    v_mul_u32_u24 v36, 896, v2
    v_lshl_add_u32 v36, v1, 4, v36
    v_lshlrev_b32 v37, 30, v4
    v_add_u32 v37, v37, v36
    s_cmp_eq_u32 s48, 3
    s_cselect_b64 vcc, -1, 0
    v_cndmask_b32 v84, v36, v37, vcc
    v_lshrrev_b32 v16, 5, v0
    s_cmp_eq_u32 s48, 3
    s_cselect_b32 s68, 15, 31
    v_and_b32 v17, s68, v0
    s_lshl_b32 s68, s48, 5
    v_add_u32 v17, s68, v17
    v_lshrrev_b32 v18, 2, v17
    v_lshlrev_b32 v18, 8, v18
    v_lshl_add_u32 v18, v16, 7, v18
    v_and_b32 v19, 3, v17
    v_lshl_add_u32 v18, v19, 4, v18
    s_lshl_b32 s68, s28, 12
    s_xor_b32 s68, s68, s58
    s_and_b32 s68, s68, 0x2000
    s_add_u32 s68, s68, 4063232
    v_add_u32 v18, s68, v18
    v_lshlrev_b32 v20, 3, v16
    v_add_u32 v20, 18432, v20
    v_lshl_add_u32 v20, v17, 5, v20
    s_mov_b32 s55, 0
    s_nop 3
Lpoll_152:
    global_load_dwordx2 v[24:25], v20, s[30:31] offset:-2048 sc1
    global_load_dwordx2 v[26:27], v20, s[30:31] offset:2048 sc1
    global_load_dwordx2 v[28:29], v20, s[30:31] offset:-2032 sc1
    global_load_dwordx2 v[30:31], v20, s[30:31] offset:2064 sc1
    s_waitcnt vmcnt(0)
    v_cmp_ne_u32 s[74:75], s53, v25
    v_cmp_ne_u32 s[78:79], s53, v27
    s_nop 0
    s_or_b64 s[74:75], s[74:75], s[78:79]
    v_cmp_ne_u32 s[80:81], s53, v29
    s_nop 0
    s_or_b64 s[74:75], s[74:75], s[80:81]
    v_cmp_ne_u32 s[76:77], s53, v31
    s_nop 0
    s_or_b64 s[74:75], s[74:75], s[76:77]
    s_cmp_eq_u64 s[74:75], 0
    s_cbranch_scc1 Lok_153
    s_add_u32 s55, s55, 1
    s_cmp_gt_u32 s55, 3000000
    s_cbranch_scc1 L_exit
    s_branch Lpoll_152
Lok_153:
    v_and_b32 v25, s14, v24
    v_lshlrev_b32 v24, 16, v24
    v_and_b32 v27, s14, v26
    v_lshlrev_b32 v26, 16, v26
    v_and_b32 v29, s14, v28
    v_lshlrev_b32 v28, 16, v28
    v_and_b32 v31, s14, v30
    v_lshlrev_b32 v30, 16, v30
    s_lshl_b32 s68, s48, 10
    s_add_u32 s68, s68, 1024
    v_and_b32 v21, 1, v2
    v_lshlrev_b32 v21, 8, v21
    v_lshrrev_b32 v19, 1, v2
    v_lshl_add_u32 v21, v19, 7, v21
    v_lshl_add_u32 v21, v1, 3, v21
    v_add_u32 v21, s68, v21
    v_lshlrev_b32 v19, 6, v19
    v_add_u32 v19, 96, v19
    v_and_b32 v20, 1, v2
    v_lshl_add_u32 v20, v20, 3, v19
    s_lshl_b32 s69, s48, 4
    v_add_u32 v20, s69, v20
    v_and_b32 v22, 1, v1
    v_lshlrev_b32 v22, 7, v22
    v_bfe_u32 v23, v1, 1, 1
    v_lshl_add_u32 v22, v23, 6, v22
    v_lshl_add_u32 v22, v2, 4, v22
    v_add_u32 v22, s68, v22
    v_add_u32 v16, 256, v22
    v_lshrrev_b32 v23, 2, v1
    v_mov_b32 v17, 256
    v_cmp_eq_u32 vcc, 0, v23
    s_nop 1
    v_cndmask_b32 v32, v17, v22, vcc
    v_cndmask_b32 v36, v17, v16, vcc
    v_cmp_eq_u32 vcc, 1, v23
    s_nop 1
    v_cndmask_b32 v33, v17, v22, vcc
    v_cndmask_b32 v37, v17, v16, vcc
    v_cmp_eq_u32 vcc, 2, v23
    s_nop 1
    v_cndmask_b32 v34, v17, v22, vcc
    v_cndmask_b32 v38, v17, v16, vcc
    v_cmp_eq_u32 vcc, 3, v23
    s_nop 1
    v_cndmask_b32 v35, v17, v22, vcc
    v_cndmask_b32 v39, v17, v16, vcc
    v_bfe_u32 v40, v0, 2, 1
    v_lshlrev_b32 v40, 9, v40
    v_lshl_add_u32 v40, v2, 7, v40
    v_lshl_add_u32 v40, v4, 6, v40
    v_and_b32 v41, 3, v0
    v_lshl_add_u32 v40, v41, 4, v40
    s_mul_i32 s69, s48, 2304
    v_add_u32 v40, s69, v40
    v_mul_u32_u24 v42, 1088, v4
    v_lshl_add_u32 v42, v2, 7, v42
    v_lshl_add_u32 v42, v41, 4, v42
    v_bfe_u32 v43, v0, 2, 1
    v_lshl_add_u32 v42, v43, 2, v42
    v_add_u32 v42, 32768, v42
    v_lshlrev_b32 v44, 6, v43
    v_lshl_add_u32 v44, v2, 4, v44
    v_lshl_add_u32 v44, v41, 2, v44
    v_lshl_add_u32 v44, v4, 1, v44
    v_add_u32 v44, s68, v44
    v_and_b32 v47, 1, v2
    v_mul_u32_u24 v47, 72, v47
    v_sub_u32 v43, v42, v47
    v_add_u32 v43, 72, v43
    v_add_u32 v42, v42, v47
    v_lshlrev_b32 v45, 6, v4
    v_lshl_add_u32 v45, v2, 4, v45
    v_add_u32 v45, s68, v45
    s_lshl_b32 s68, s49, 7
    s_lshl_b32 s69, s48, 17
    s_add_u32 s68, s68, s69
    s_add_u32 s68, s68, 3604480
    s_add_u32 s68, s68, s58
    v_lshlrev_b32 v46, 15, v2
    v_lshl_add_u32 v46, v4, 14, v46
    v_lshl_add_u32 v46, v3, 4, v46
    v_add_u32 v46, s68, v46
    v_xor_b32 v47, 0x2000, v46
    s_mov_b32 s55, 0
Lspin_154:
    ds_read_b32 v85, v63 offset:20
    s_add_u32 s55, s55, 1
    s_cmp_gt_u32 s55, 48000000
    s_cbranch_scc1 L_exit
    s_waitcnt lgkmcnt(0)
    v_readfirstlane_b32 s72, v85
    s_nop 0
    s_cmp_ge_u32 s72, 4
    s_cbranch_scc1 Lsok_155
    s_sleep 1
    s_branch Lspin_154
Lsok_155:
    s_mul_i32 s69, s49, 28672
    s_lshl_b32 s70, s48, 8
    s_add_u32 s69, s69, s70
    s_waitcnt vmcnt(9)
    buffer_load_dwordx4 v[96:99], v84, s[44:47], s69 offen nt
    s_add_u32 s69, s69, 3584
    s_waitcnt vmcnt(9)
    buffer_load_dwordx4 v[100:103], v84, s[44:47], s69 offen nt
    s_add_u32 s69, s69, 3584
    s_waitcnt vmcnt(9)
    buffer_load_dwordx4 v[104:107], v84, s[44:47], s69 offen nt
    s_add_u32 s69, s69, 3584
    s_waitcnt vmcnt(9)
    buffer_load_dwordx4 v[108:111], v84, s[44:47], s69 offen nt
    s_add_u32 s69, s69, 3584
    s_waitcnt vmcnt(9)
    buffer_load_dwordx4 v[112:115], v84, s[44:47], s69 offen nt
    s_add_u32 s69, s69, 3584
    s_waitcnt vmcnt(9)
    buffer_load_dwordx4 v[116:119], v84, s[44:47], s69 offen nt
    s_add_u32 s69, s69, 3584
    s_waitcnt vmcnt(9)
    buffer_load_dwordx4 v[120:123], v84, s[44:47], s69 offen nt
    s_add_u32 s69, s69, 3584
    s_waitcnt vmcnt(9)
    buffer_load_dwordx4 v[124:127], v84, s[44:47], s69 offen nt
    s_mov_b32 s55, 0
Lspin_156:
    ds_read_b32 v85, v63 offset:16
    s_add_u32 s55, s55, 1
    s_cmp_gt_u32 s55, 48000000
    s_cbranch_scc1 L_exit
    s_waitcnt lgkmcnt(0)
    v_readfirstlane_b32 s72, v85
    s_nop 0
    s_cmp_ge_u32 s72, 12
    s_cbranch_scc1 Lsok_157
    s_sleep 1
    s_branch Lspin_156
Lsok_157:
    v_lshlrev_b32 v86, 5, v4
    v_lshl_add_u32 v86, v2, 3, v86
    s_lshl_b32 s69, s48, 7
    v_add_u32 v86, s69, v86
    v_mul_u32_u24 v86, 3584, v86
    v_and_b32 v87, 3, v0
    v_lshl_add_u32 v86, v87, 4, v86
    s_lshl_b32 s69, s49, 6
    v_add_u32 v86, s69, v86
    v_cmp_gt_u32 vcc, 4, v3
    v_mov_b32 v88, s18
    v_mov_b32 v89, s16
    v_cndmask_b32 v88, v88, v89, vcc
    v_mov_b32 v89, s19
    v_mov_b32 v90, s17
    v_cndmask_b32 v89, v89, v90, vcc
    v_add_co_u32 v88, vcc, v88, v86
    s_nop 1
    v_addc_co_u32 v89, vcc, 0, v89, vcc
    s_waitcnt vmcnt(15)
    global_load_dwordx4 v[128:131], v[88:89], off nt
    v_add_co_u32 v88, vcc, 3584, v88
    s_nop 1
    v_addc_co_u32 v89, vcc, 0, v89, vcc
    s_waitcnt vmcnt(15)
    global_load_dwordx4 v[132:135], v[88:89], off nt
    v_add_co_u32 v88, vcc, 3584, v88
    s_nop 1
    v_addc_co_u32 v89, vcc, 0, v89, vcc
    s_waitcnt vmcnt(15)
    global_load_dwordx4 v[136:139], v[88:89], off nt
    v_add_co_u32 v88, vcc, 3584, v88
    s_nop 1
    v_addc_co_u32 v89, vcc, 0, v89, vcc
    s_waitcnt vmcnt(15)
    global_load_dwordx4 v[140:143], v[88:89], off nt
    v_add_co_u32 v88, vcc, 3584, v88
    s_nop 1
    v_addc_co_u32 v89, vcc, 0, v89, vcc
    s_waitcnt vmcnt(15)
    global_load_dwordx4 v[144:147], v[88:89], off nt
    v_add_co_u32 v88, vcc, 3584, v88
    s_nop 1
    v_addc_co_u32 v89, vcc, 0, v89, vcc
    s_waitcnt vmcnt(15)
    global_load_dwordx4 v[148:151], v[88:89], off nt
    v_add_co_u32 v88, vcc, 3584, v88
    s_nop 1
    v_addc_co_u32 v89, vcc, 0, v89, vcc
    s_waitcnt vmcnt(15)
    global_load_dwordx4 v[152:155], v[88:89], off nt
    v_add_co_u32 v88, vcc, 3584, v88
    s_nop 1
    v_addc_co_u32 v89, vcc, 0, v89, vcc
    s_waitcnt vmcnt(15)
    global_load_dwordx4 v[156:159], v[88:89], off nt
    v_add_co_u32 v88, vcc, 204288, v88
    s_nop 1
    v_addc_co_u32 v89, vcc, 0, v89, vcc
    s_cmp_eq_u32 s48, 3
    s_cbranch_scc1 L_fw2
    s_waitcnt vmcnt(15)
    global_load_dwordx4 v[160:163], v[88:89], off nt
    v_add_co_u32 v88, vcc, 3584, v88
    s_nop 1
    v_addc_co_u32 v89, vcc, 0, v89, vcc
    s_waitcnt vmcnt(15)
    global_load_dwordx4 v[164:167], v[88:89], off nt
    v_add_co_u32 v88, vcc, 3584, v88
    s_nop 1
    v_addc_co_u32 v89, vcc, 0, v89, vcc
    s_waitcnt vmcnt(15)
    global_load_dwordx4 v[168:171], v[88:89], off nt
    v_add_co_u32 v88, vcc, 3584, v88
    s_nop 1
    v_addc_co_u32 v89, vcc, 0, v89, vcc
    s_waitcnt vmcnt(15)
    global_load_dwordx4 v[172:175], v[88:89], off nt
    v_add_co_u32 v88, vcc, 3584, v88
    s_nop 1
    v_addc_co_u32 v89, vcc, 0, v89, vcc
    s_waitcnt vmcnt(15)
    global_load_dwordx4 v[176:179], v[88:89], off nt
    v_add_co_u32 v88, vcc, 3584, v88
    s_nop 1
    v_addc_co_u32 v89, vcc, 0, v89, vcc
    s_waitcnt vmcnt(15)
    global_load_dwordx4 v[180:183], v[88:89], off nt
    v_add_co_u32 v88, vcc, 3584, v88
    s_nop 1
    v_addc_co_u32 v89, vcc, 0, v89, vcc
    s_waitcnt vmcnt(15)
    global_load_dwordx4 v[184:187], v[88:89], off nt
    v_add_co_u32 v88, vcc, 3584, v88
    s_nop 1
    v_addc_co_u32 v89, vcc, 0, v89, vcc
    s_waitcnt vmcnt(15)
    global_load_dwordx4 v[188:191], v[88:89], off nt
L_fw2:
    s_mov_b32 s70, 0x05040100
    s_mov_b32 s71, 0x07060302
    s_cmp_eq_u32 s48, 3
    s_cbranch_scc0 L_ft0
    s_waitcnt vmcnt(0)
L_ft0:
    s_waitcnt vmcnt(8)
    v_perm_b32 v192, v132, v128, s70
    v_perm_b32 v193, v140, v136, s70
    v_perm_b32 v194, v148, v144, s70
    v_perm_b32 v195, v156, v152, s70
    v_perm_b32 v196, v132, v128, s71
    v_perm_b32 v197, v140, v136, s71
    v_perm_b32 v198, v148, v144, s71
    v_perm_b32 v199, v156, v152, s71
    v_perm_b32 v200, v133, v129, s70
    v_perm_b32 v201, v141, v137, s70
    v_perm_b32 v202, v149, v145, s70
    v_perm_b32 v203, v157, v153, s70
    v_perm_b32 v204, v133, v129, s71
    v_perm_b32 v205, v141, v137, s71
    v_perm_b32 v206, v149, v145, s71
    v_perm_b32 v207, v157, v153, s71
    v_perm_b32 v208, v134, v130, s70
    v_perm_b32 v209, v142, v138, s70
    v_perm_b32 v210, v150, v146, s70
    v_perm_b32 v211, v158, v154, s70
    v_perm_b32 v212, v134, v130, s71
    v_perm_b32 v213, v142, v138, s71
    v_perm_b32 v214, v150, v146, s71
    v_perm_b32 v215, v158, v154, s71
    v_perm_b32 v216, v135, v131, s70
    v_perm_b32 v217, v143, v139, s70
    v_perm_b32 v218, v151, v147, s70
    v_perm_b32 v219, v159, v155, s70
    v_perm_b32 v220, v135, v131, s71
    v_perm_b32 v221, v143, v139, s71
    v_perm_b32 v222, v151, v147, s71
    v_perm_b32 v223, v159, v155, s71
    s_waitcnt vmcnt(0)
    v_perm_b32 v224, v164, v160, s70
    v_perm_b32 v225, v172, v168, s70
    v_perm_b32 v226, v180, v176, s70
    v_perm_b32 v227, v188, v184, s70
    v_perm_b32 v228, v164, v160, s71
    v_perm_b32 v229, v172, v168, s71
    v_perm_b32 v230, v180, v176, s71
    v_perm_b32 v231, v188, v184, s71
    v_perm_b32 v232, v165, v161, s70
    v_perm_b32 v233, v173, v169, s70
    v_perm_b32 v234, v181, v177, s70
    v_perm_b32 v235, v189, v185, s70
    v_perm_b32 v236, v165, v161, s71
    v_perm_b32 v237, v173, v169, s71
    v_perm_b32 v238, v181, v177, s71
    v_perm_b32 v239, v189, v185, s71
    v_perm_b32 v240, v166, v162, s70
    v_perm_b32 v241, v174, v170, s70
    v_perm_b32 v242, v182, v178, s70
    v_perm_b32 v243, v190, v186, s70
    v_perm_b32 v244, v166, v162, s71
    v_perm_b32 v245, v174, v170, s71
    v_perm_b32 v246, v182, v178, s71
    v_perm_b32 v247, v190, v186, s71
    v_perm_b32 v248, v167, v163, s70
    v_perm_b32 v249, v175, v171, s70
    v_perm_b32 v250, v183, v179, s70
    v_perm_b32 v251, v191, v187, s70
    v_perm_b32 v252, v167, v163, s71
    v_perm_b32 v253, v175, v171, s71
    v_perm_b32 v254, v183, v179, s71
    v_perm_b32 v255, v191, v187, s71
    v_mov_b32 v161, s53
    v_mov_b32 v163, s53
    v_mov_b32 v165, s53
    v_mov_b32 v167, s53
    s_mov_b32 s70, 0x3f803f80
    s_mov_b32 s72, 0x00010001
    s_mov_b32 s73, 0x00010001
    s_mov_b32 s55, 0
Lpc_158:
    global_load_dwordx4 v[168:171], v18, s[8:9] sc1
    s_waitcnt vmcnt(0)
    v_cmpx_eq_u32 s[74:75], s53, v169
    v_cmpx_eq_u32 s[74:75], s53, v171
    s_mov_b64 exec, -1
    s_cmp_eq_u64 s[74:75], -1
    s_cbranch_scc1 Lpk_160
    s_add_u32 s55, s55, 1
    s_cmp_gt_u32 s55, 3000000
    s_cbranch_scc0 Lpc_158
    s_branch L_exit
Lpk_160:
    v_dot2_f32_bf16 v48, v168, s70, 0
    v_dot2_f32_bf16 v49, v168, v168, 0
    v_dot2_f32_bf16 v48, v170, s70, v48
    v_dot2_f32_bf16 v49, v170, v170, v49
    v_lshlrev_b32 v80, 16, v168
    v_and_b32 v81, s14, v168
    v_lshlrev_b32 v82, 16, v170
    v_and_b32 v83, s14, v170
Lpd_159:
    v_add_f32_dpp v48, v48, v48 quad_perm:[1,0,3,2] row_mask:0xf bank_mask:0xf
    v_add_f32_dpp v49, v49, v49 quad_perm:[1,0,3,2] row_mask:0xf bank_mask:0xf
    s_nop 0
    v_add_f32_dpp v48, v48, v48 quad_perm:[2,3,0,1] row_mask:0xf bank_mask:0xf
    v_add_f32_dpp v49, v49, v49 quad_perm:[2,3,0,1] row_mask:0xf bank_mask:0xf
    s_nop 0
    v_add_f32_dpp v48, v48, v48 row_half_mirror row_mask:0xf bank_mask:0xf
    v_add_f32_dpp v49, v49, v49 row_half_mirror row_mask:0xf bank_mask:0xf
    s_nop 0
    v_add_f32_dpp v48, v48, v48 row_mirror row_mask:0xf bank_mask:0xf
    v_add_f32_dpp v49, v49, v49 row_mirror row_mask:0xf bank_mask:0xf
    s_mov_b64 exec, s[72:73]
    ds_write_b64 v20, v[48:49]
    s_mov_b64 exec, -1
    s_waitcnt lgkmcnt(0)
    s_barrier
    ds_read_b128 v[48:51], v19
    ds_read_b128 v[52:55], v19 offset:16
    ds_read_b128 v[56:59], v19 offset:32
    ds_read_b64 v[60:61], v19 offset:48
    s_waitcnt lgkmcnt(2)
    v_pk_add_f32 v[48:49], v[48:49], v[50:51]
    v_pk_add_f32 v[52:53], v[52:53], v[54:55]
    s_waitcnt lgkmcnt(0)
    v_pk_add_f32 v[56:57], v[56:57], v[58:59]
    v_pk_add_f32 v[48:49], v[48:49], v[52:53]
    v_pk_add_f32 v[56:57], v[56:57], v[60:61]
    v_pk_add_f32 v[48:49], v[48:49], v[56:57]
    v_mul_f32 v48, 0x3b124925, v48
    v_mul_f32 v49, 0x3b124925, v49
    v_fma_f32 v49, -v48, v48, v49
    v_max_f32 v49, 0, v49
    v_cvt_pk_bf16_f32 v49, v48, v49
    v_lshlrev_b32 v48, 16, v49
    v_and_b32 v49, s14, v49
    v_add_f32 v49, 0x3727c5ac, v49
    v_sub_f32 v80, v80, v48
    v_cvt_pk_bf16_f32 v49, v49, v49
    v_sub_f32 v81, v81, v48
    v_and_b32 v49, s14, v49
    v_sub_f32 v82, v82, v48
    v_sqrt_f32 v49, v49
    v_sub_f32 v83, v83, v48
    v_cvt_pk_bf16_f32 v81, v80, v81
    v_cvt_pk_bf16_f32 v49, v49, v49
    v_cvt_pk_bf16_f32 v83, v82, v83
    v_and_b32 v49, s14, v49
    v_lshlrev_b32 v80, 16, v81
    v_rcp_f32 v49, v49
    v_and_b32 v81, s14, v81
    v_lshlrev_b32 v82, 16, v83
    v_and_b32 v83, s14, v83
    v_mul_f32 v80, v80, v49
    v_mul_f32 v81, v81, v49
    v_mul_f32 v82, v82, v49
    v_mul_f32 v83, v83, v49
    v_cvt_pk_bf16_f32 v81, v80, v81
    v_lshlrev_b32 v80, 16, v81
    v_and_b32 v81, s14, v81
    v_cvt_pk_bf16_f32 v83, v82, v83
    v_lshlrev_b32 v82, 16, v83
    v_and_b32 v83, s14, v83
    v_mul_f32 v80, v80, v26
    v_mul_f32 v81, v81, v27
    v_mul_f32 v82, v82, v30
    v_mul_f32 v83, v83, v31
    v_cvt_pk_bf16_f32 v81, v80, v81
    v_lshlrev_b32 v80, 16, v81
    v_and_b32 v81, s14, v81
    v_cvt_pk_bf16_f32 v83, v82, v83
    v_lshlrev_b32 v82, 16, v83
    v_and_b32 v83, s14, v83
    v_add_f32 v80, v80, v24
    v_add_f32 v81, v81, v25
    v_add_f32 v82, v82, v28
    v_add_f32 v83, v83, v29
    v_cvt_pk_bf16_f32 v80, v80, v81
    v_cvt_pk_bf16_f32 v81, v82, v83
    ds_write_b64 v21, v[80:81]
    ds_read_b128 v[128:131], v32
    ds_read_b128 v[132:135], v33
    ds_read_b128 v[136:139], v34
    ds_read_b128 v[140:143], v35
    ds_read_b128 v[144:147], v36
    ds_read_b128 v[148:151], v37
    ds_read_b128 v[152:155], v38
    ds_read_b128 v[156:159], v39
    s_waitcnt lgkmcnt(7)
    v_mfma_f32_16x16x32_bf16 v[48:51], v[128:131], v[192:195], 0
    v_mfma_f32_16x16x32_bf16 v[52:55], v[128:131], v[208:211], 0
    s_waitcnt lgkmcnt(6)
    v_mfma_f32_16x16x32_bf16 v[48:51], v[132:135], v[196:199], v[48:51]
    v_mfma_f32_16x16x32_bf16 v[52:55], v[132:135], v[212:215], v[52:55]
    s_waitcnt lgkmcnt(5)
    v_mfma_f32_16x16x32_bf16 v[48:51], v[136:139], v[200:203], v[48:51]
    v_mfma_f32_16x16x32_bf16 v[52:55], v[136:139], v[216:219], v[52:55]
    s_waitcnt lgkmcnt(4)
    v_mfma_f32_16x16x32_bf16 v[48:51], v[140:143], v[204:207], v[48:51]
    v_mfma_f32_16x16x32_bf16 v[52:55], v[140:143], v[220:223], v[52:55]
    s_cmp_eq_u32 s48, 3
    s_cbranch_scc1 L_fm2
    s_waitcnt lgkmcnt(3)
    v_mfma_f32_16x16x32_bf16 v[48:51], v[144:147], v[224:227], v[48:51]
    v_mfma_f32_16x16x32_bf16 v[52:55], v[144:147], v[240:243], v[52:55]
    s_waitcnt lgkmcnt(2)
    v_mfma_f32_16x16x32_bf16 v[48:51], v[148:151], v[228:231], v[48:51]
    v_mfma_f32_16x16x32_bf16 v[52:55], v[148:151], v[244:247], v[52:55]
    s_waitcnt lgkmcnt(1)
    v_mfma_f32_16x16x32_bf16 v[48:51], v[152:155], v[232:235], v[48:51]
    v_mfma_f32_16x16x32_bf16 v[52:55], v[152:155], v[248:251], v[52:55]
    s_waitcnt lgkmcnt(0)
    v_mfma_f32_16x16x32_bf16 v[48:51], v[156:159], v[236:239], v[48:51]
    v_mfma_f32_16x16x32_bf16 v[52:55], v[156:159], v[252:255], v[52:55]
L_fm2:
    s_nop 6
    ds_write_b128 v40, v[48:51] offset:32768
    ds_write_b128 v40, v[52:55] offset:33856
    s_waitcnt lgkmcnt(0)
    s_barrier
    ds_read2st64_b32 v[64:65], v42 offset0:0 offset1:2
    ds_read2st64_b32 v[66:67], v43 offset0:0 offset1:2
    ds_read2st64_b32 v[68:69], v42 offset0:9 offset1:11
    ds_read2st64_b32 v[70:71], v43 offset0:9 offset1:11
    ds_read2st64_b32 v[72:73], v42 offset0:18 offset1:20
    ds_read2st64_b32 v[74:75], v43 offset0:18 offset1:20
    ds_read2st64_b32 v[76:77], v42 offset0:27 offset1:29
    ds_read2st64_b32 v[78:79], v43 offset0:27 offset1:29
    s_waitcnt lgkmcnt(4)
    v_pk_add_f32 v[64:65], v[64:65], v[66:67]
    v_pk_add_f32 v[68:69], v[68:69], v[70:71]
    s_waitcnt lgkmcnt(0)
    v_pk_add_f32 v[72:73], v[72:73], v[74:75]
    v_pk_add_f32 v[76:77], v[76:77], v[78:79]
    v_pk_add_f32 v[64:65], v[64:65], v[68:69]
    v_pk_add_f32 v[72:73], v[72:73], v[76:77]
    v_pk_add_f32 v[64:65], v[64:65], v[72:73]
    v_cvt_pk_bf16_f32 v65, v64, v65
    v_lshlrev_b32 v64, 16, v65
    v_and_b32 v65, s14, v65
    v_mul_f32 v66, 0xbfb8aa3b, v64
    v_exp_f32 v66, v66
    s_nop 0
    v_add_f32 v66, 1.0, v66
    v_rcp_f32 v66, v66
    s_nop 0
    v_mul_f32 v64, v64, v66
    v_cvt_pk_bf16_f32 v64, v64, v64
    v_and_b32 v64, s14, v64
    v_mul_f32 v64, v64, v65
    v_cvt_pk_bf16_f32 v64, v64, v64
    ds_write_b16 v44, v64 offset:512
    ds_read_b128 v[68:71], v45 offset:512
    s_waitcnt lgkmcnt(0)
    v_perm_b32 v72, v68, v68, v8
    v_perm_b32 v73, v68, v68, v9
    v_perm_b32 v74, v68, v68, v10
    v_perm_b32 v75, v68, v68, v11
    v_perm_b32 v76, v68, v68, v12
    v_perm_b32 v77, v68, v68, v13
    v_perm_b32 v78, v68, v68, v14
    v_perm_b32 v79, v68, v68, v15
    v_mfma_f32_16x16x32_bf16 v[88:91], v[96:99], v[72:75], 0
    v_perm_b32 v80, v69, v69, v8
    v_perm_b32 v81, v69, v69, v9
    v_perm_b32 v82, v69, v69, v10
    v_perm_b32 v83, v69, v69, v11
    v_mfma_f32_16x16x32_bf16 v[88:91], v[100:103], v[76:79], v[88:91]
    v_perm_b32 v84, v69, v69, v12
    v_perm_b32 v85, v69, v69, v13
    v_perm_b32 v86, v69, v69, v14
    v_perm_b32 v87, v69, v69, v15
    v_mfma_f32_16x16x32_bf16 v[88:91], v[104:107], v[80:83], v[88:91]
    v_perm_b32 v72, v70, v70, v8
    v_perm_b32 v73, v70, v70, v9
    v_perm_b32 v74, v70, v70, v10
    v_perm_b32 v75, v70, v70, v11
    v_mfma_f32_16x16x32_bf16 v[88:91], v[108:111], v[84:87], v[88:91]
    v_perm_b32 v76, v70, v70, v12
    v_perm_b32 v77, v70, v70, v13
    v_perm_b32 v78, v70, v70, v14
    v_perm_b32 v79, v70, v70, v15
    v_mfma_f32_16x16x32_bf16 v[88:91], v[112:115], v[72:75], v[88:91]
    v_perm_b32 v80, v71, v71, v8
    v_perm_b32 v81, v71, v71, v9
    v_perm_b32 v82, v71, v71, v10
    v_perm_b32 v83, v71, v71, v11
    v_mfma_f32_16x16x32_bf16 v[88:91], v[116:119], v[76:79], v[88:91]
    v_perm_b32 v84, v71, v71, v12
    v_perm_b32 v85, v71, v71, v13
    v_perm_b32 v86, v71, v71, v14
    v_perm_b32 v87, v71, v71, v15
    v_mfma_f32_16x16x32_bf16 v[88:91], v[120:123], v[80:83], v[88:91]
    s_nop 0
    v_mfma_f32_16x16x32_bf16 v[88:91], v[124:127], v[84:87], v[88:91]
    s_cmp_eq_u32 s48, 3
    s_cselect_b32 exec_hi, 0, -1
    s_nop 5
    v_mov_b32 v160, v88
    v_mov_b32 v162, v89
    v_mov_b32 v164, v90
    v_mov_b32 v166, v91
    global_store_dwordx4 v46, v[160:163], s[8:9] sc1
    global_store_dwordx4 v47, v[164:167], s[8:9] sc1
    s_mov_b64 exec, -1
L_exit:
L_end:
    s_endpgm
L_codeend:
.fill (24576+64-(L_codeend-adaLN_cond__gqa_block_cached__swiglu_ffn__decode_kernel))/4, 4, 0xbf810000
.section .rodata,"a"
.p2align 6
.amdhsa_kernel adaLN_cond__gqa_block_cached__swiglu_ffn__decode_kernel
  .amdhsa_next_free_vgpr 256
  .amdhsa_next_free_sgpr 102
  .amdhsa_accum_offset 256
  .amdhsa_group_segment_fixed_size 0
  .amdhsa_kernarg_size 112
  .amdhsa_user_sgpr_count 2
  .amdhsa_user_sgpr_kernarg_segment_ptr 1
  .amdhsa_system_sgpr_workgroup_id_x 1
  .amdhsa_float_denorm_mode_32 3
.end_amdhsa_kernel
```
